```python
import torch

def _softmax(x, axis=-1):
    return torch.softmax(x, dim=axis)
def _gelu(x):
    return torch.nn.functional.gelu(x, approximate="tanh")
def _silu(x):
    return torch.nn.functional.silu(x)
def _sigmoid(x):
    return torch.sigmoid(x)
def _layernorm(x, axis=-1, eps=1e-5):
    m = x.mean(dim=axis, keepdim=True)
    v = x.var(dim=axis, keepdim=True, unbiased=False)
    return (x - m) / torch.sqrt(v + eps)
def _scatter_add(tgt, idx, src, axis=0):
    return tgt.clone().index_add_(axis, idx, src)
def _segment_sum(src, seg, n):
    out = torch.zeros((n,) + src.shape[1:], dtype=src.dtype)
    return out.index_add_(0, seg, src)
def _pad(x, pw):
    flat = tuple(v for pair in reversed(pw) for v in pair)
    return torch.nn.functional.pad(x, flat)

kernel_name = 'gated_mix__softmax_full_mha__geglu_ffn__prompt'

def setup_inputs():

    _w = (lambda a: (lambda t: t.to(torch.bfloat16) if t.is_floating_point() else t)(torch.as_tensor(a)))
    def _A_setup():
        B, S, D = 1, 2048, 512
        return {
            "x": _w((lambda *s: torch.randn(*s, dtype=torch.bfloat16) * 0.05)(B, S, D)),
            "wqkv": _w((lambda *s: torch.randn(*s, dtype=torch.bfloat16) * 0.8)(D, 3 * D)),
            "wo": _w((lambda *s: torch.randn(*s, dtype=torch.bfloat16) * 0.05)(D, D)),
        }
    _A_in = _A_setup()

    def _B_setup():
        B, S, D, F = 1, 2048, 512, 1792
        return {
            "x": _w((lambda *s: torch.randn(*s, dtype=torch.bfloat16) * 0.05)(B, S, D)),
            "w_gate": _w((lambda *s: torch.randn(*s, dtype=torch.bfloat16) * 0.1)(D, F)),
            "w_up": _w((lambda *s: torch.randn(*s, dtype=torch.bfloat16) * 0.1)(D, F)),
            "w_down": _w((lambda *s: torch.randn(*s, dtype=torch.bfloat16) * 0.1)(F, D)),
        }
    _B_in = _B_setup()

    return {
        "A_x": _A_in["x"],
        "A_wqkv": _A_in["wqkv"],
        "A_wo": _A_in["wo"],
        "B_x": _B_in["x"],
        "B_w_gate": _B_in["w_gate"],
        "B_w_up": _B_in["w_up"],
        "B_w_down": _B_in["w_down"],
        "gate_w": _w((lambda *s: torch.randn(*s, dtype=torch.bfloat16) * 0.05)(512) * 16.0),
    }

def reference(A_x, A_wqkv, A_wo, B_x, B_w_gate, B_w_up, B_w_down, gate_w):
    def _A_ref(x, wqkv, wo):
        B, S, D = x.shape
        H = 32; Dh = D // H
        qkv = (lambda x, *d: x.permute(*d))((x @ wqkv).reshape(B, S, 3, H, Dh), 2, 0, 3, 1, 4)
        q, k, v = qkv[0], qkv[1], qkv[2]
        scale = Dh ** -0.5
        scores = torch.einsum("bhqd,bhkd->bhqk", q, k) * scale
        p = _softmax(scores, axis=-1)
        o = torch.einsum("bhqk,bhkd->bhqd", p, v)
        return (lambda x, *d: x.permute(*d))(o, 0, 2, 1, 3).reshape(B, S, D) @ wo

    def _B_ref(x, w_gate, w_up, w_down):
        return (_gelu(x @ w_gate) * (x @ w_up)) @ w_down

    x = A_x
    g = _sigmoid((x * gate_w).sum(-1, keepdims=True))
    a = _A_ref(x, A_wqkv, A_wo)
    b = _B_ref(x, B_w_gate, B_w_up, B_w_down)
    return g * a + (1 - g) * b
```

```asm
; @launch grid=(256,1,1) block=(512,1,1) lds=163840
.amdgcn_target "amdgcn-amd-amdhsa--gfx950"
.text
.globl gated_mix__softmax_full_mha__geglu_ffn__prompt_kernel
.p2align 8
.type gated_mix__softmax_full_mha__geglu_ffn__prompt_kernel,@function
gated_mix__softmax_full_mha__geglu_ffn__prompt_kernel:
  s_cmp_ge_u32 s2, 256
  s_cbranch_scc1 K_EXIT
  s_load_dwordx4 s[4:7], s[0:1], 0
  v_lshrrev_b32 v1, 6, v0
  v_and_b32 v2, 63, v0
  v_readfirstlane_b32 s20, v1
  s_load_dwordx4 s[12:15], s[0:1], 32
  s_load_dwordx2 s[8:9], s[0:1], 16
  s_load_dwordx2 s[10:11], s[0:1], 80
  s_load_dwordx4 s[16:19], s[0:1], 48
  s_load_dwordx4 s[64:67], s[0:1], 64
  v_lshlrev_b32 v3, 4, v2
  s_and_b32 s24, s2, 1
  s_bfe_u32 s25, s2, 0x20001
  s_lshr_b32 s26, s2, 3
  s_and_b32 s63, s26, 7
  s_lshl_b32 s21, s24, 3
  s_add_u32 s21, s21, s63
  s_lshr_b32 s27, s26, 3
  s_mul_i32 s22, s25, 3
  s_add_u32 s22, s22, s27
  s_sub_u32 s22, s22, 1
  s_add_u32 s23, s25, 12
  s_cmp_eq_u32 s27, 0
  s_cselect_b32 s22, s23, s22
  s_lshl_b32 s72, s25, 3
  s_add_u32 s72, s72, s63
  s_lshl_b32 s73, s24, 2
  s_add_u32 s73, s73, s27
  s_add_u32 s63, s63, s27
  s_lshl_b32 s63, s63, 1
  s_and_b32 s63, s63, 7
  s_and_b32 s70, s2, 7
  s_lshl_b32 s70, s70, 2
  s_lshr_b32 s27, s26, 3
  s_add_u32 s27, s27, s26
  s_and_b32 s27, s27, 3
  s_add_u32 s70, s70, s27
  s_and_b32 s71, s26, 7
  s_cmp_lt_u32 s20, 4
  s_cbranch_scc1 K1_COMPUTE
  s_sub_u32 s23, s20, 4
  v_lshrrev_b32 v4, 3, v2
  v_and_b32 v5, 7, v2
  v_lshrrev_b32 v6, 4, v2
  v_xor_b32 v7, v5, v6
  v_lshlrev_b32 v7, 4, v7
  v_lshl_add_u32 v10, v4, 10, v7
  v_xor_b32 v11, 64, v10
  v_and_b32 v7, 1, v6
  v_lshlrev_b32 v7, 2, v7
  v_xor_b32 v7, v7, v5
  v_lshlrev_b32 v7, 4, v7
  v_mul_u32_u24 v8, 3072, v4
  v_add_u32 v14, v8, v7
  v_mul_u32_u24 v8, 3584, v4
  v_add_u32 v15, v8, v7
  s_cmp_lt_u32 s22, 12
  s_cselect_b64 vcc, -1, 0
  s_movk_i32 s60, 3072
  s_cselect_b32 s60, 3584, s60
  v_cndmask_b32 v12, v14, v15, vcc
  v_xor_b32 v13, 32, v12
  s_cselect_b32 s32, 0, 12
  s_sub_u32 s32, s22, s32
  s_lshl_b32 s32, s32, 8
  s_lshl_b32 s61, s22, 1
  s_add_u32 s61, s61, 1
  s_add_u32 s34, s22, 12
  s_cmp_lt_u32 s22, 12
  s_cselect_b32 s33, 0, 128
  s_cselect_b32 s61, s61, s34
  s_lshl_b32 s61, s61, 7
  s_mul_i32 s34, s23, 57344
  s_add_u32 s61, s61, s34
  s_lshl_b32 s34, s23, 4
  s_mul_i32 s34, s34, s60
  s_add_u32 s32, s32, s34
  s_lshl_b32 s62, s60, 6
  s_lshl_b32 s36, s60, 3
  s_mul_i32 s34, s23, 49152
  s_lshl_b32 s35, s22, 7
  s_add_u32 s34, s34, s35
  s_add_u32 s34, s34, 1024
  s_lshl_b32 s40, s21, 17
  s_lshl_b32 s41, s23, 15
  s_add_u32 s40, s40, s41
  s_lshl_b32 s42, s23, 12
  s_lshl_b32 s35, s23, 11
  s_mov_b32 s43, s63
  s_waitcnt lgkmcnt(0)
  s_mov_b32 s24, s4
  s_mov_b32 s25, s5
  s_mov_b32 s26, 0x200000
  s_mov_b32 s27, 0x20000
  s_mov_b32 s44, s6
  s_mov_b32 s45, s7
  s_mov_b32 s46, 0x180000
  s_mov_b32 s47, 0x20000
  s_cmp_lt_u32 s22, 12
  s_cselect_b64 s[48:49], s[12:13], s[6:7]
  s_cselect_b64 s[52:53], s[14:15], s[6:7]
  s_cselect_b32 s50, 0x1c0000, s46
  s_mov_b32 s54, s50
  s_mov_b32 s51, 0x20000
  s_mov_b32 s55, 0x20000
  s_mul_i32 s38, s43, s62
  s_add_u32 s38, s38, s32
  s_add_u32 m0, s35, 81920
  s_add_u32 s39, s38, s33
  buffer_load_dwordx4 v12, s[48:51], s38 offen lds
  s_add_u32 m0, s35, 90112
  s_add_u32 s38, s38, s36
  buffer_load_dwordx4 v13, s[52:55], s39 offen lds
  s_add_u32 m0, s35, 82944
  s_add_u32 s39, s38, s33
  buffer_load_dwordx4 v12, s[48:51], s38 offen lds
  s_add_u32 m0, s35, 91136
  s_add_u32 s38, s38, s36
  buffer_load_dwordx4 v13, s[52:55], s39 offen lds
  s_mul_i32 s38, s43, 196608
  s_add_u32 s38, s38, s34
  s_add_u32 m0, s35, 98304
  s_add_u32 s39, s38, 0
  buffer_load_dwordx4 v14, s[44:47], s39 offen lds
  s_add_u32 m0, s35, 99328
  s_add_u32 s39, s38, 24576
  buffer_load_dwordx4 v14, s[44:47], s39 offen lds
  s_lshl_b32 s37, s43, 7
  s_add_u32 s37, s37, s40
  s_add_u32 m0, s42, 49152
  s_add_u32 s39, s37, 0
  buffer_load_dwordx4 v10, s[24:27], s39 offen lds
  s_add_u32 m0, s42, 50176
  s_add_u32 s39, s37, 8192
  buffer_load_dwordx4 v11, s[24:27], s39 offen lds
  s_add_u32 m0, s42, 51200
  s_add_u32 s39, s37, 16384
  buffer_load_dwordx4 v10, s[24:27], s39 offen lds
  s_add_u32 m0, s42, 52224
  s_add_u32 s39, s37, 24576
  buffer_load_dwordx4 v11, s[24:27], s39 offen lds
  s_add_u32 s43, s43, 1
  s_and_b32 s43, s43, 7
  s_mul_i32 s38, s43, s62
  s_add_u32 s38, s38, s32
  s_add_u32 m0, s35, 106496
  s_add_u32 s39, s38, s33
  buffer_load_dwordx4 v12, s[48:51], s38 offen lds
  s_add_u32 m0, s35, 114688
  s_add_u32 s38, s38, s36
  buffer_load_dwordx4 v13, s[52:55], s39 offen lds
  s_add_u32 m0, s35, 107520
  s_add_u32 s39, s38, s33
  buffer_load_dwordx4 v12, s[48:51], s38 offen lds
  s_add_u32 m0, s35, 115712
  s_add_u32 s38, s38, s36
  buffer_load_dwordx4 v13, s[52:55], s39 offen lds
  s_mul_i32 s38, s43, 196608
  s_add_u32 s38, s38, s34
  s_add_u32 m0, s35, 122880
  s_add_u32 s39, s38, 0
  buffer_load_dwordx4 v14, s[44:47], s39 offen lds
  s_add_u32 m0, s35, 123904
  s_add_u32 s39, s38, 24576
  buffer_load_dwordx4 v14, s[44:47], s39 offen lds
  s_lshl_b32 s37, s43, 7
  s_add_u32 s37, s37, s40
  s_add_u32 m0, s42, 32768
  s_add_u32 s39, s37, 0
  buffer_load_dwordx4 v10, s[24:27], s39 offen lds
  s_add_u32 m0, s42, 33792
  s_add_u32 s39, s37, 8192
  buffer_load_dwordx4 v11, s[24:27], s39 offen lds
  s_add_u32 m0, s42, 34816
  s_add_u32 s39, s37, 16384
  buffer_load_dwordx4 v10, s[24:27], s39 offen lds
  s_add_u32 m0, s42, 35840
  s_add_u32 s39, s37, 24576
  buffer_load_dwordx4 v11, s[24:27], s39 offen lds
  s_add_u32 s43, s43, 1
  s_and_b32 s43, s43, 7
  s_mov_b32 s28, s10
  s_mov_b32 s29, s11
  s_mov_b32 s30, 0x2800000
  s_mov_b32 s31, 0x20000
  v_mov_b32 v9, 0
  s_add_u32 s37, s2, s20
  s_cmp_eq_u32 s37, 4
  s_cbranch_scc0 K1_NOTAG
  s_memrealtime s[56:57]
  s_waitcnt lgkmcnt(0)
  s_or_b32 s56, s56, 1
  s_or_b32 s57, s57, 0x80000000
  v_mov_b32 v4, s56
  v_mov_b32 v5, s57
  s_mov_b64 exec, 1
  global_store_dwordx2 v9, v[4:5], s[66:67] sc1
  s_mov_b64 exec, -1
K1_NOTAG:
  v_mul_u32_u24 v36, 2080, v2
  v_add_u32 v36, 2048, v36
  v_mov_b32 v40, 0x3f803f80
  v_mov_b32 v44, 0
  v_mov_b32 v41, 0x3f803f80
  v_mov_b32 v45, 0
  v_mov_b32 v42, 0x3f803f80
  v_mov_b32 v46, 0
  v_mov_b32 v43, 0x3f803f80
  v_mov_b32 v47, 0
  s_mul_i32 s37, s23, 6144
  s_add_u32 s37, s37, 137472
  v_lshrrev_b32 v4, 3, v2
  v_and_b32 v5, 7, v2
  v_bfe_u32 v7, v2, 4, 1
  v_lshlrev_b32 v7, 2, v7
  v_xor_b32 v5, v5, v7
  v_lshlrev_b32 v5, 4, v5
  v_lshl_add_u32 v248, v4, 10, v5
  v_add_u32 v249, 7168, v248
  v_bfe_u32 v4, v2, 2, 2
  v_lshrrev_b32 v5, 5, v2
  v_lshl_add_u32 v5, v5, 2, v4
  v_lshlrev_b32 v5, 7, v5
  v_lshrrev_b32 v4, 1, v4
  v_lshl_add_u32 v5, v4, 6, v5
  v_bfe_u32 v4, v2, 4, 1
  v_lshl_add_u32 v5, v4, 5, v5
  v_and_b32 v4, 3, v2
  v_lshl_add_u32 v5, v4, 3, v5
  v_xor_b32 v251, 64, v5
  v_add_u32 v250, s37, v5
  v_add_u32 v251, s37, v251
  s_lshl_b32 s37, s23, 14
  v_lshrrev_b32 v212, 5, v2
  v_and_b32 v213, 7, v2
  v_xor_b32 v212, v212, v213
  v_and_b32 v213, 31, v2
  v_lshlrev_b32 v213, 8, v213
  v_lshl_add_u32 v212, v212, 4, v213
  v_xor_b32 v213, 32, v212
  v_xor_b32 v214, 64, v212
  v_xor_b32 v215, 96, v212
  v_add_u32 v212, s37, v212
  v_add_u32 v213, s37, v213
  v_add_u32 v214, s37, v214
  v_add_u32 v215, s37, v215
  v_and_b32 v224, 15, v2
  v_lshlrev_b32 v224, 7, v224
  v_and_b32 v225, 31, v2
  v_lshlrev_b32 v225, 3, v225
  v_lshlrev_b32 v226, 3, v2
  s_lshl_b32 s37, s23, 8
  s_add_u32 s37, s37, 162176
  v_lshlrev_b32 v227, 2, v2
  v_add_u32 v227, s37, v227
  v_mov_b32 v228, 163592
  v_mov_b32 v229, 1
  v_mov_b32 v230, 16
  v_mov_b32 v231, 256
  v_mov_b32 v232, 4096
  v_and_b32 v233, 7, v2
  v_lshlrev_b32 v233, 7, v233
  v_and_b32 v5, 15, v2
  v_lshlrev_b32 v5, 7, v5
  v_bfe_u32 v6, v2, 4, 1
  v_lshl_add_u32 v5, v6, 14, v5
  s_and_b32 s56, s2, 7
  s_lshr_b32 s57, s56, 1
  s_add_u32 s57, s57, 12
  s_sub_u32 s57, s57, s56
  s_lshl_b32 s57, s57, 11
  s_lshl_b32 s58, s71, 8
  s_add_u32 s57, s57, s58
  s_add_u32 s57, s57, 40960
  v_and_b32 v6, 1, v2
  v_lshlrev_b32 v6, 7, v6
  v_add_u32 v6, s57, v6
  v_cmp_gt_u32 vcc, 32, v2
  s_lshl_b32 s56, s56, 11
  s_add_u32 s56, s56, 16252928
  v_cndmask_b32 v5, v6, v5, vcc
  s_mul_i32 s57, s70, 66560
  s_lshl_b32 s58, s23, 10
  s_add_u32 s57, s57, s58
  s_add_u32 s57, s57, 0
  s_mul_i32 s58, s23, 2080
  s_waitcnt vmcnt(10)
  s_barrier
  s_mul_i32 s38, s43, s62
  s_add_u32 s38, s38, s32
  s_add_u32 m0, s35, 131072
  s_add_u32 s39, s38, s33
  buffer_load_dwordx4 v12, s[48:51], s38 offen lds
  s_add_u32 m0, s35, 139264
  s_add_u32 s38, s38, s36
  buffer_load_dwordx4 v13, s[52:55], s39 offen lds
  s_add_u32 m0, s35, 132096
  s_add_u32 s39, s38, s33
  buffer_load_dwordx4 v12, s[48:51], s38 offen lds
  s_add_u32 m0, s35, 140288
  s_add_u32 s38, s38, s36
  buffer_load_dwordx4 v13, s[52:55], s39 offen lds
  s_mul_i32 s38, s43, 196608
  s_add_u32 s38, s38, s34
  s_add_u32 m0, s35, 147456
  s_add_u32 s39, s38, 0
  buffer_load_dwordx4 v14, s[44:47], s39 offen lds
  s_add_u32 m0, s35, 148480
  s_add_u32 s39, s38, 24576
  buffer_load_dwordx4 v14, s[44:47], s39 offen lds
  s_lshl_b32 s37, s43, 7
  s_add_u32 s37, s37, s40
  s_add_u32 m0, s42, 0
  s_add_u32 s39, s37, 0
  buffer_load_dwordx4 v10, s[24:27], s39 offen lds
  s_add_u32 m0, s42, 1024
  s_add_u32 s39, s37, 8192
  buffer_load_dwordx4 v11, s[24:27], s39 offen lds
  s_add_u32 m0, s42, 2048
  s_add_u32 s39, s37, 16384
  buffer_load_dwordx4 v10, s[24:27], s39 offen lds
  s_add_u32 m0, s42, 3072
  s_add_u32 s39, s37, 24576
  buffer_load_dwordx4 v11, s[24:27], s39 offen lds
  s_add_u32 s43, s43, 1
  s_and_b32 s43, s43, 7
  s_waitcnt vmcnt(10)
  s_barrier
  s_mul_i32 s38, s43, s62
  s_add_u32 s38, s38, s32
  s_add_u32 m0, s35, 81920
  s_add_u32 s39, s38, s33
  buffer_load_dwordx4 v12, s[48:51], s38 offen lds
  s_add_u32 m0, s35, 90112
  s_add_u32 s38, s38, s36
  buffer_load_dwordx4 v13, s[52:55], s39 offen lds
  s_add_u32 m0, s35, 82944
  s_add_u32 s39, s38, s33
  buffer_load_dwordx4 v12, s[48:51], s38 offen lds
  s_add_u32 m0, s35, 91136
  s_add_u32 s38, s38, s36
  buffer_load_dwordx4 v13, s[52:55], s39 offen lds
  s_mul_i32 s38, s43, 196608
  s_add_u32 s38, s38, s34
  s_add_u32 m0, s35, 98304
  s_add_u32 s39, s38, 0
  buffer_load_dwordx4 v14, s[44:47], s39 offen lds
  s_add_u32 m0, s35, 99328
  s_add_u32 s39, s38, 24576
  buffer_load_dwordx4 v14, s[44:47], s39 offen lds
  s_lshl_b32 s37, s43, 7
  s_add_u32 s37, s37, s40
  s_add_u32 m0, s42, 16384
  s_add_u32 s39, s37, 0
  buffer_load_dwordx4 v10, s[24:27], s39 offen lds
  s_add_u32 m0, s42, 17408
  s_add_u32 s39, s37, 8192
  buffer_load_dwordx4 v11, s[24:27], s39 offen lds
  s_add_u32 m0, s42, 18432
  s_add_u32 s39, s37, 16384
  buffer_load_dwordx4 v10, s[24:27], s39 offen lds
  s_add_u32 m0, s42, 19456
  s_add_u32 s39, s37, 24576
  buffer_load_dwordx4 v11, s[24:27], s39 offen lds
  s_add_u32 s43, s43, 1
  s_and_b32 s43, s43, 7
  s_waitcnt vmcnt(10)
  s_barrier
  s_mul_i32 s38, s43, s62
  s_add_u32 s38, s38, s32
  s_add_u32 m0, s35, 106496
  s_add_u32 s39, s38, s33
  buffer_load_dwordx4 v12, s[48:51], s38 offen lds
  s_add_u32 m0, s35, 114688
  s_add_u32 s38, s38, s36
  buffer_load_dwordx4 v13, s[52:55], s39 offen lds
  s_add_u32 m0, s35, 107520
  s_add_u32 s39, s38, s33
  buffer_load_dwordx4 v12, s[48:51], s38 offen lds
  s_add_u32 m0, s35, 115712
  s_add_u32 s38, s38, s36
  buffer_load_dwordx4 v13, s[52:55], s39 offen lds
  s_mul_i32 s38, s43, 196608
  s_add_u32 s38, s38, s34
  s_add_u32 m0, s35, 122880
  s_add_u32 s39, s38, 0
  buffer_load_dwordx4 v14, s[44:47], s39 offen lds
  s_add_u32 m0, s35, 123904
  s_add_u32 s39, s38, 24576
  buffer_load_dwordx4 v14, s[44:47], s39 offen lds
  s_lshl_b32 s37, s43, 7
  s_add_u32 s37, s37, s40
  s_add_u32 m0, s42, 65536
  s_add_u32 s39, s37, 0
  buffer_load_dwordx4 v10, s[24:27], s39 offen lds
  s_add_u32 m0, s42, 66560
  s_add_u32 s39, s37, 8192
  buffer_load_dwordx4 v11, s[24:27], s39 offen lds
  s_add_u32 m0, s42, 67584
  s_add_u32 s39, s37, 16384
  buffer_load_dwordx4 v10, s[24:27], s39 offen lds
  s_add_u32 m0, s42, 68608
  s_add_u32 s39, s37, 24576
  buffer_load_dwordx4 v11, s[24:27], s39 offen lds
  s_add_u32 s43, s43, 1
  s_and_b32 s43, s43, 7
  s_waitcnt vmcnt(10)
  s_barrier
  s_mul_i32 s38, s43, s62
  s_add_u32 s38, s38, s32
  s_add_u32 m0, s35, 131072
  s_add_u32 s39, s38, s33
  buffer_load_dwordx4 v12, s[48:51], s38 offen lds
  s_add_u32 m0, s35, 139264
  s_add_u32 s38, s38, s36
  buffer_load_dwordx4 v13, s[52:55], s39 offen lds
  s_add_u32 m0, s35, 132096
  s_add_u32 s39, s38, s33
  buffer_load_dwordx4 v12, s[48:51], s38 offen lds
  s_add_u32 m0, s35, 140288
  s_add_u32 s38, s38, s36
  buffer_load_dwordx4 v13, s[52:55], s39 offen lds
  s_mul_i32 s38, s43, 196608
  s_add_u32 s38, s38, s34
  s_add_u32 m0, s35, 147456
  s_add_u32 s39, s38, 0
  buffer_load_dwordx4 v14, s[44:47], s39 offen lds
  s_add_u32 m0, s35, 148480
  s_add_u32 s39, s38, 24576
  buffer_load_dwordx4 v14, s[44:47], s39 offen lds
  s_lshl_b32 s37, s43, 7
  s_add_u32 s37, s37, s40
  s_add_u32 m0, s42, 49152
  s_add_u32 s39, s37, 0
  buffer_load_dwordx4 v10, s[24:27], s39 offen lds
  s_add_u32 m0, s42, 50176
  s_add_u32 s39, s37, 8192
  buffer_load_dwordx4 v11, s[24:27], s39 offen lds
  s_add_u32 m0, s42, 51200
  s_add_u32 s39, s37, 16384
  buffer_load_dwordx4 v10, s[24:27], s39 offen lds
  s_add_u32 m0, s42, 52224
  s_add_u32 s39, s37, 24576
  buffer_load_dwordx4 v11, s[24:27], s39 offen lds
  s_add_u32 s43, s43, 1
  s_and_b32 s43, s43, 7
  s_waitcnt vmcnt(10)
  s_barrier
  global_load_dwordx2 v[60:61], v9, s[66:67] sc1
  s_mul_i32 s38, s43, s62
  s_add_u32 s38, s38, s32
  s_add_u32 m0, s35, 81920
  s_add_u32 s39, s38, s33
  buffer_load_dwordx4 v12, s[48:51], s38 offen lds
  s_add_u32 m0, s35, 90112
  s_add_u32 s38, s38, s36
  buffer_load_dwordx4 v13, s[52:55], s39 offen lds
  s_add_u32 m0, s35, 82944
  s_add_u32 s39, s38, s33
  buffer_load_dwordx4 v12, s[48:51], s38 offen lds
  s_add_u32 m0, s35, 91136
  s_add_u32 s38, s38, s36
  buffer_load_dwordx4 v13, s[52:55], s39 offen lds
  s_mul_i32 s38, s43, 196608
  s_add_u32 s38, s38, s34
  s_add_u32 m0, s35, 98304
  s_add_u32 s39, s38, 0
  buffer_load_dwordx4 v14, s[44:47], s39 offen lds
  s_add_u32 m0, s35, 99328
  s_add_u32 s39, s38, 24576
  buffer_load_dwordx4 v14, s[44:47], s39 offen lds
  s_lshl_b32 s37, s43, 7
  s_add_u32 s37, s37, s40
  s_add_u32 m0, s42, 32768
  s_add_u32 s39, s37, 0
  buffer_load_dwordx4 v10, s[24:27], s39 offen lds
  s_add_u32 m0, s42, 33792
  s_add_u32 s39, s37, 8192
  buffer_load_dwordx4 v11, s[24:27], s39 offen lds
  s_add_u32 m0, s42, 34816
  s_add_u32 s39, s37, 16384
  buffer_load_dwordx4 v10, s[24:27], s39 offen lds
  s_add_u32 m0, s42, 35840
  s_add_u32 s39, s37, 24576
  buffer_load_dwordx4 v11, s[24:27], s39 offen lds
  s_add_u32 s43, s43, 1
  s_and_b32 s43, s43, 7
  s_waitcnt vmcnt(10)
  s_barrier
  s_mul_i32 s38, s43, s62
  s_add_u32 s38, s38, s32
  s_add_u32 m0, s35, 106496
  s_add_u32 s39, s38, s33
  buffer_load_dwordx4 v12, s[48:51], s38 offen lds
  s_add_u32 m0, s35, 114688
  s_add_u32 s38, s38, s36
  buffer_load_dwordx4 v13, s[52:55], s39 offen lds
  s_add_u32 m0, s35, 107520
  s_add_u32 s39, s38, s33
  buffer_load_dwordx4 v12, s[48:51], s38 offen lds
  s_add_u32 m0, s35, 115712
  s_add_u32 s38, s38, s36
  buffer_load_dwordx4 v13, s[52:55], s39 offen lds
  s_mul_i32 s38, s43, 196608
  s_add_u32 s38, s38, s34
  s_add_u32 m0, s35, 122880
  s_add_u32 s39, s38, 0
  buffer_load_dwordx4 v14, s[44:47], s39 offen lds
  s_add_u32 m0, s35, 123904
  s_add_u32 s39, s38, 24576
  buffer_load_dwordx4 v14, s[44:47], s39 offen lds
  s_lshl_b32 s37, s43, 7
  s_add_u32 s37, s37, s40
  s_add_u32 m0, s42, 0
  s_add_u32 s39, s37, 0
  buffer_load_dwordx4 v10, s[24:27], s39 offen lds
  s_add_u32 m0, s42, 1024
  s_add_u32 s39, s37, 8192
  buffer_load_dwordx4 v11, s[24:27], s39 offen lds
  s_add_u32 m0, s42, 2048
  s_add_u32 s39, s37, 16384
  buffer_load_dwordx4 v10, s[24:27], s39 offen lds
  s_add_u32 m0, s42, 3072
  s_add_u32 s39, s37, 24576
  buffer_load_dwordx4 v11, s[24:27], s39 offen lds
  s_mov_b32 s32, s61
  s_mov_b32 s33, 0
  s_mov_b32 s62, 229376
  s_mov_b32 s36, 28672
  s_mov_b64 s[48:49], s[12:13]
  s_mov_b64 s[52:53], s[14:15]
  s_mov_b32 s50, 0x1c0000
  s_mov_b32 s54, 0x1c0000
  v_mov_b32 v12, v15
  v_xor_b32 v13, 32, v15
  s_bitcmp1_b32 s23, 0
  s_cselect_b64 s[92:93], s[14:15], s[12:13]
  s_mov_b32 s94, 0x1c0000
  s_mov_b32 s95, 0x20000
  v_and_b32 v16, 31, v2
  v_mul_u32_u24 v16, 3584, v16
  s_mul_i32 s37, s23, 57344
  s_sub_u32 s37, s61, s37
  s_and_b32 s38, s21, 7
  s_lshl_b32 s38, s38, 1
  s_lshr_b32 s39, s23, 1
  s_add_u32 s38, s38, s39
  s_mul_i32 s38, s38, 114688
  s_add_u32 s37, s37, s38
  buffer_load_dword v17, v16, s[92:95], s37 offen
  s_waitcnt vmcnt(11)
  s_mov_b32 s74, 200000
  v_readfirstlane_b32 s68, v60
  v_readfirstlane_b32 s69, v61
TAG_1:
  s_sub_u32 s74, s74, 1
  s_cbranch_scc1 TAGD_2
  s_min_u32 s75, s68, s69
  s_cmp_lg_u32 s75, 0
  s_cbranch_scc1 TAGD_2
  global_load_dwordx2 v[60:61], v9, s[66:67] sc1
  s_waitcnt vmcnt(0)
  v_readfirstlane_b32 s68, v60
  v_readfirstlane_b32 s69, v61
  s_sleep 2
  s_branch TAG_1
TAGD_2:
  v_mov_b32 v4, 163584
  v_mov_b32 v60, s68
  v_mov_b32 v61, s69
  ds_write_b64 v4, v[60:61]
  ds_write_b32 v4, v9 offset:8
  ds_write_b32 v4, v9 offset:12
  ds_write_b32 v4, v9 offset:16
  ds_write_b32 v4, v9 offset:20
  ds_write_b32 v4, v9 offset:24
  ds_write_b32 v4, v9 offset:28
  s_waitcnt lgkmcnt(0)
  s_barrier
  s_mul_i32 s38, s43, s62
  s_add_u32 s38, s38, s32
  s_add_u32 m0, s35, 131072
  s_add_u32 s39, s38, s33
  buffer_load_dwordx4 v12, s[48:51], s38 offen lds
  s_add_u32 m0, s35, 139264
  s_add_u32 s38, s38, s36
  buffer_load_dwordx4 v13, s[52:55], s39 offen lds
  s_add_u32 m0, s35, 132096
  s_add_u32 s39, s38, s33
  buffer_load_dwordx4 v12, s[48:51], s38 offen lds
  s_add_u32 m0, s35, 140288
  s_add_u32 s38, s38, s36
  buffer_load_dwordx4 v13, s[52:55], s39 offen lds
  s_add_u32 s43, s43, 7
  s_and_b32 s43, s43, 7
  s_waitcnt vmcnt(5)
  s_barrier
  s_mul_i32 s38, s43, s62
  s_add_u32 s38, s38, s32
  s_add_u32 m0, s35, 81920
  s_add_u32 s39, s38, s33
  buffer_load_dwordx4 v12, s[48:51], s38 offen lds
  s_add_u32 m0, s35, 90112
  s_add_u32 s38, s38, s36
  buffer_load_dwordx4 v13, s[52:55], s39 offen lds
  s_add_u32 m0, s35, 82944
  s_add_u32 s39, s38, s33
  buffer_load_dwordx4 v12, s[48:51], s38 offen lds
  s_add_u32 m0, s35, 91136
  s_add_u32 s38, s38, s36
  buffer_load_dwordx4 v13, s[52:55], s39 offen lds
  s_add_u32 s43, s43, 7
  s_and_b32 s43, s43, 7
  s_mov_b32 s44, s18
  s_mov_b32 s45, s19
  s_mov_b32 s46, 0x400
  s_mov_b32 s47, 0x20000
  s_lshl_b32 s76, s21, 4
  s_add_u32 s76, s76, s22
  s_lshl_b32 s76, s76, 2
  s_add_u32 s76, s76, s23
  s_lshl_b32 s37, s76, 11
  buffer_load_dwordx4 v[64:67], v3, s[44:47], 0 offen
  buffer_load_dwordx4 v[24:27], v3, s[24:27], s37 offen
  buffer_load_dwordx4 v[28:31], v3, s[24:27], s37 offen offset:1024
  s_waitcnt vmcnt(7)
  s_barrier
  s_mul_i32 s38, s43, s62
  s_add_u32 s38, s38, s32
  s_add_u32 m0, s35, 98304
  s_add_u32 s39, s38, s33
  buffer_load_dwordx4 v12, s[48:51], s38 offen lds
  s_add_u32 m0, s35, 106496
  s_add_u32 s38, s38, s36
  buffer_load_dwordx4 v13, s[52:55], s39 offen lds
  s_add_u32 m0, s35, 99328
  s_add_u32 s39, s38, s33
  buffer_load_dwordx4 v12, s[48:51], s38 offen lds
  s_add_u32 m0, s35, 107520
  s_add_u32 s38, s38, s36
  buffer_load_dwordx4 v13, s[52:55], s39 offen lds
  s_add_u32 s43, s43, 7
  s_and_b32 s43, s43, 7
  s_mul_i32 s38, s43, s62
  s_add_u32 s38, s38, s32
  s_add_u32 m0, s35, 114688
  s_add_u32 s39, s38, s33
  buffer_load_dwordx4 v12, s[48:51], s38 offen lds
  s_add_u32 m0, s35, 122880
  s_add_u32 s38, s38, s36
  buffer_load_dwordx4 v13, s[52:55], s39 offen lds
  s_add_u32 m0, s35, 115712
  s_add_u32 s39, s38, s33
  buffer_load_dwordx4 v12, s[48:51], s38 offen lds
  s_add_u32 m0, s35, 123904
  s_add_u32 s38, s38, s36
  buffer_load_dwordx4 v13, s[52:55], s39 offen lds
  s_add_u32 s43, s43, 7
  s_and_b32 s43, s43, 7
  s_waitcnt vmcnt(11)
  s_barrier
  s_mul_i32 s38, s43, s62
  s_add_u32 s38, s38, s32
  s_add_u32 m0, s35, 131072
  s_add_u32 s39, s38, s33
  buffer_load_dwordx4 v12, s[48:51], s38 offen lds
  s_add_u32 m0, s35, 139264
  s_add_u32 s38, s38, s36
  buffer_load_dwordx4 v13, s[52:55], s39 offen lds
  s_add_u32 m0, s35, 132096
  s_add_u32 s39, s38, s33
  buffer_load_dwordx4 v12, s[48:51], s38 offen lds
  s_add_u32 m0, s35, 140288
  s_add_u32 s38, s38, s36
  buffer_load_dwordx4 v13, s[52:55], s39 offen lds
  s_add_u32 s43, s43, 7
  s_and_b32 s43, s43, 7
  s_waitcnt vmcnt(12)
  v_mov_b32 v32, 0
  v_mov_b32 v33, 0
  v_dot2_f32_bf16 v32, v24, v64, v32
  v_dot2_f32_bf16 v33, v28, v64, v33
  v_dot2_f32_bf16 v32, v25, v65, v32
  v_dot2_f32_bf16 v33, v29, v65, v33
  v_dot2_f32_bf16 v32, v26, v66, v32
  v_dot2_f32_bf16 v33, v30, v66, v33
  v_dot2_f32_bf16 v32, v27, v67, v32
  v_dot2_f32_bf16 v33, v31, v67, v33
  s_nop 2
  v_permlane32_swap_b32 v32, v33
  s_nop 1
  v_add_f32 v32, v32, v33
  s_nop 1
  v_add_f32_dpp v32, v32, v32 quad_perm:[1,0,3,2] row_mask:0xf bank_mask:0xf
  s_nop 1
  v_add_f32_dpp v32, v32, v32 quad_perm:[2,3,0,1] row_mask:0xf bank_mask:0xf
  s_nop 1
  v_add_f32_dpp v32, v32, v32 row_half_mirror row_mask:0xf bank_mask:0xf
  s_nop 1
  v_add_f32_dpp v32, v32, v32 row_mirror row_mask:0xf bank_mask:0xf
  v_mov_b32 v33, v32
  s_nop 1
  v_permlane16_swap_b32 v32, v33
  s_nop 1
  v_add_f32 v32, v32, v33
  v_mul_f32 v32, 0xbfb8aa3b, v32
  v_exp_f32 v32, v32
  v_lshrrev_b32 v70, 5, v2
  v_add_f32 v32, 1.0, v32
  v_rcp_f32 v68, v32
  v_lshlrev_b32 v70, 3, v70
  v_mov_b32 v69, s68
  s_waitcnt vmcnt(8)
  s_barrier
  s_cmp_lg_u32 s23, 1
  s_cbranch_scc1 FA_3
  s_lshl_b32 s37, s22, 4
  s_add_u32 s37, s37, s21
  s_lshl_b32 s37, s37, 7
  s_add_u32 s37, s37, 16252928
  v_mov_b32 v16, s68
  v_mov_b32 v17, s69
  v_mov_b32 v18, 0
  s_mov_b64 exec, 1
  buffer_store_dwordx2 v[16:17], v18, s[28:31], s37 offen sc1
  s_mov_b64 exec, -1
FA_3:
  s_mul_i32 s38, s43, s62
  s_add_u32 s38, s38, s32
  s_add_u32 m0, s35, 81920
  s_add_u32 s39, s38, s33
  buffer_load_dwordx4 v12, s[48:51], s38 offen lds
  s_add_u32 m0, s35, 90112
  s_add_u32 s38, s38, s36
  buffer_load_dwordx4 v13, s[52:55], s39 offen lds
  s_add_u32 m0, s35, 82944
  s_add_u32 s39, s38, s33
  buffer_load_dwordx4 v12, s[48:51], s38 offen lds
  s_add_u32 m0, s35, 91136
  s_add_u32 s38, s38, s36
  buffer_load_dwordx4 v13, s[52:55], s39 offen lds
  s_lshl_b32 s37, s43, 7
  s_add_u32 s37, s37, s40
  s_add_u32 m0, s42, 32768
  s_add_u32 s39, s37, 0
  buffer_load_dwordx4 v10, s[24:27], s39 offen lds
  s_add_u32 m0, s42, 33792
  s_add_u32 s39, s37, 8192
  buffer_load_dwordx4 v11, s[24:27], s39 offen lds
  s_add_u32 m0, s42, 34816
  s_add_u32 s39, s37, 16384
  buffer_load_dwordx4 v10, s[24:27], s39 offen lds
  s_add_u32 m0, s42, 35840
  s_add_u32 s39, s37, 24576
  buffer_load_dwordx4 v11, s[24:27], s39 offen lds
  s_add_u32 s43, s43, 7
  s_and_b32 s43, s43, 7
  s_waitcnt vmcnt(12)
  s_barrier
  s_cmp_lg_u32 s23, 1
  s_cbranch_scc1 FA_4
  s_cmp_lt_u32 s22, 12
  s_cbranch_scc1 FA_4
  s_lshl_b32 s37, s22, 4
  s_add_u32 s37, s37, s21
  s_lshl_b32 s37, s37, 7
  s_add_u32 s37, s37, 16293888
  v_mov_b32 v16, s68
  v_mov_b32 v17, s69
  v_mov_b32 v18, 0
  s_mov_b64 exec, 1
  buffer_store_dwordx2 v[16:17], v18, s[28:31], s37 offen sc1
  s_mov_b64 exec, -1
FA_4:
  s_mul_i32 s38, s43, s62
  s_add_u32 s38, s38, s32
  s_add_u32 m0, s35, 98304
  s_add_u32 s39, s38, s33
  buffer_load_dwordx4 v12, s[48:51], s38 offen lds
  s_add_u32 m0, s35, 106496
  s_add_u32 s38, s38, s36
  buffer_load_dwordx4 v13, s[52:55], s39 offen lds
  s_add_u32 m0, s35, 99328
  s_add_u32 s39, s38, s33
  buffer_load_dwordx4 v12, s[48:51], s38 offen lds
  s_add_u32 m0, s35, 107520
  s_add_u32 s38, s38, s36
  buffer_load_dwordx4 v13, s[52:55], s39 offen lds
  s_lshl_b32 s37, s43, 7
  s_add_u32 s37, s37, s40
  s_add_u32 m0, s42, 49152
  s_add_u32 s39, s37, 0
  buffer_load_dwordx4 v10, s[24:27], s39 offen lds
  s_add_u32 m0, s42, 50176
  s_add_u32 s39, s37, 8192
  buffer_load_dwordx4 v11, s[24:27], s39 offen lds
  s_add_u32 m0, s42, 51200
  s_add_u32 s39, s37, 16384
  buffer_load_dwordx4 v10, s[24:27], s39 offen lds
  s_add_u32 m0, s42, 52224
  s_add_u32 s39, s37, 24576
  buffer_load_dwordx4 v11, s[24:27], s39 offen lds
  s_add_u32 s43, s43, 7
  s_and_b32 s43, s43, 7
  s_waitcnt vmcnt(16)
  s_barrier
  s_mul_i32 s38, s43, s62
  s_add_u32 s38, s38, s32
  s_add_u32 m0, s35, 114688
  s_add_u32 s39, s38, s33
  buffer_load_dwordx4 v12, s[48:51], s38 offen lds
  s_add_u32 m0, s35, 122880
  s_add_u32 s38, s38, s36
  buffer_load_dwordx4 v13, s[52:55], s39 offen lds
  s_add_u32 m0, s35, 115712
  s_add_u32 s39, s38, s33
  buffer_load_dwordx4 v12, s[48:51], s38 offen lds
  s_add_u32 m0, s35, 123904
  s_add_u32 s38, s38, s36
  buffer_load_dwordx4 v13, s[52:55], s39 offen lds
  s_lshl_b32 s37, s43, 7
  s_add_u32 s37, s37, s40
  s_add_u32 m0, s42, 65536
  s_add_u32 s39, s37, 0
  buffer_load_dwordx4 v10, s[24:27], s39 offen lds
  s_add_u32 m0, s42, 66560
  s_add_u32 s39, s37, 8192
  buffer_load_dwordx4 v11, s[24:27], s39 offen lds
  s_add_u32 m0, s42, 67584
  s_add_u32 s39, s37, 16384
  buffer_load_dwordx4 v10, s[24:27], s39 offen lds
  s_add_u32 m0, s42, 68608
  s_add_u32 s39, s37, 24576
  buffer_load_dwordx4 v11, s[24:27], s39 offen lds
  s_add_u32 s43, s43, 7
  s_and_b32 s43, s43, 7
  v_mov_b32 v22, 163608
  v_mov_b32 v23, 16
  s_waitcnt vmcnt(8)
  s_barrier
  s_waitcnt vmcnt(0)
  s_mov_b64 exec, 1
  ds_add_u32 v22, v23
  s_mov_b64 exec, -1
  v_mov_b32 v19, 163592
  s_cmp_lg_u32 s23, 0
  s_cbranch_scc1 KV_OTHER
  s_mov_b32 s74, 200000
  s_mov_b32 s77, 0
KV_POLL:
  buffer_load_dwordx2 v[8:9], v5, s[28:31], s56 offen sc1
  s_waitcnt vmcnt(0)
  v_cmp_ne_u64 vcc, s[68:69], v[8:9]
  s_sub_u32 s74, s74, 1
  s_cselect_b64 vcc, 0, vcc
  s_cmp_lg_u32 vcc_lo, 0
  s_cbranch_scc1 KV_AGAIN
  s_cmp_eq_u32 vcc_hi, 0
  s_cselect_b32 s75, 2, 1
  v_mov_b32 v16, s75
  ds_write_b32 v19, v16
  s_cmp_lg_u32 s77, 0
  s_mov_b32 s77, s75
  s_cbranch_scc1 KV_HAVE
  s_mul_i32 s44, s71, 3
  s_lshr_b32 s44, s44, 3
  s_mul_i32 s45, s44, 8320
  s_add_u32 s45, s45, s58
  s_add_u32 m0, s45, 0
  s_lshl_b32 s37, s44, 12
  s_add_u32 s37, s37, s57
  s_add_u32 s38, s37, 0
  buffer_load_dwordx4 v3, s[28:31], s38 offen sc1 lds
  s_add_u32 m0, s45, 1024
  s_add_u32 s38, s37, 2162688
  buffer_load_dwordx4 v3, s[28:31], s38 offen sc1 lds
  s_add_u32 s44, s44, 1
  s_cmp_eq_u32 s44, 3
  s_cselect_b32 s44, 0, s44
  s_mul_i32 s45, s44, 8320
  s_add_u32 s45, s45, s58
  s_add_u32 m0, s45, 0
  s_lshl_b32 s37, s44, 12
  s_add_u32 s37, s37, s57
  s_add_u32 s38, s37, 0
  buffer_load_dwordx4 v3, s[28:31], s38 offen sc1 lds
  s_add_u32 m0, s45, 1024
  s_add_u32 s38, s37, 2162688
  buffer_load_dwordx4 v3, s[28:31], s38 offen sc1 lds
  s_add_u32 s44, s44, 1
  s_cmp_eq_u32 s44, 3
  s_cselect_b32 s44, 0, s44
  s_mul_i32 s45, s44, 8320
  s_add_u32 s45, s45, s58
  s_add_u32 m0, s45, 0
  s_lshl_b32 s37, s44, 12
  s_add_u32 s37, s37, s57
  s_add_u32 s38, s37, 0
  buffer_load_dwordx4 v3, s[28:31], s38 offen sc1 lds
  s_add_u32 m0, s45, 1024
  s_add_u32 s38, s37, 2162688
  buffer_load_dwordx4 v3, s[28:31], s38 offen sc1 lds
KV_HAVE:
  s_cmp_eq_u32 s77, 2
  s_cbranch_scc1 KV_Q
KV_AGAIN:
  s_sleep 1
  s_branch KV_POLL
KV_OTHER:
  s_mov_b32 s74, 1600000
  ds_read_b32 v16, v19
LW_5:
  s_waitcnt lgkmcnt(0)
  v_readfirstlane_b32 s75, v16
  s_sub_u32 s74, s74, 1
  s_cbranch_scc1 LWD_6
  s_cmp_ge_u32 s75, 1
  s_cbranch_scc1 LWD_6
  s_sleep 1
  ds_read_b32 v16, v19
  s_branch LW_5
LWD_6:
  s_mul_i32 s44, s71, 3
  s_lshr_b32 s44, s44, 3
  s_mul_i32 s45, s44, 8320
  s_add_u32 s45, s45, s58
  s_add_u32 m0, s45, 0
  s_lshl_b32 s37, s44, 12
  s_add_u32 s37, s37, s57
  s_add_u32 s38, s37, 0
  buffer_load_dwordx4 v3, s[28:31], s38 offen sc1 lds
  s_add_u32 m0, s45, 1024
  s_add_u32 s38, s37, 2162688
  buffer_load_dwordx4 v3, s[28:31], s38 offen sc1 lds
  s_add_u32 s44, s44, 1
  s_cmp_eq_u32 s44, 3
  s_cselect_b32 s44, 0, s44
  s_mul_i32 s45, s44, 8320
  s_add_u32 s45, s45, s58
  s_add_u32 m0, s45, 0
  s_lshl_b32 s37, s44, 12
  s_add_u32 s37, s37, s57
  s_add_u32 s38, s37, 0
  buffer_load_dwordx4 v3, s[28:31], s38 offen sc1 lds
  s_add_u32 m0, s45, 1024
  s_add_u32 s38, s37, 2162688
  buffer_load_dwordx4 v3, s[28:31], s38 offen sc1 lds
  s_add_u32 s44, s44, 1
  s_cmp_eq_u32 s44, 3
  s_cselect_b32 s44, 0, s44
  s_mul_i32 s45, s44, 8320
  s_add_u32 s45, s45, s58
  s_add_u32 m0, s45, 0
  s_lshl_b32 s37, s44, 12
  s_add_u32 s37, s37, s57
  s_add_u32 s38, s37, 0
  buffer_load_dwordx4 v3, s[28:31], s38 offen sc1 lds
  s_add_u32 m0, s45, 1024
  s_add_u32 s38, s37, 2162688
  buffer_load_dwordx4 v3, s[28:31], s38 offen sc1 lds
  s_mov_b32 s74, 1600000
  ds_read_b32 v16, v19
LW_7:
  s_waitcnt lgkmcnt(0)
  v_readfirstlane_b32 s75, v16
  s_sub_u32 s74, s74, 1
  s_cbranch_scc1 LWD_8
  s_cmp_ge_u32 s75, 2
  s_cbranch_scc1 LWD_8
  s_sleep 1
  ds_read_b32 v16, v19
  s_branch LW_7
LWD_8:
KV_Q:
  s_mul_i32 s37, s70, 65
  s_lshl_b32 s38, s71, 3
  s_add_u32 s37, s37, s38
  s_lshl_b32 s38, s23, 1
  s_add_u32 s37, s37, s38
  s_lshl_b32 s37, s37, 10
  s_lshl_b32 s38, s23, 11
  s_add_u32 m0, s38, 147456
  s_add_u32 s37, s37, 4325376
  buffer_load_dwordx4 v3, s[28:31], s37 offen sc1 lds
  buffer_load_dwordx4 v3, s[28:31], s37 offen offset:1024 sc1 lds
  s_branch K2_GEMM
K1_COMPUTE:
  s_and_b32 s23, s20, 1
  s_lshr_b32 s24, s20, 1
  v_bfe_u32 v16, v2, 4, 1
  v_lshrrev_b32 v17, 5, v2
  v_bfe_u32 v18, v2, 2, 2
  v_and_b32 v19, 3, v2
  v_lshl_add_u32 v20, v17, 3, v18
  v_and_b32 v21, 31, v2
  v_lshlrev_b32 v21, 7, v21
  v_bfe_u32 v22, v2, 1, 3
  v_xor_b32 v22, v22, v17
  v_lshl_add_u32 v21, v22, 4, v21
  s_lshl_b32 s25, s23, 13
  s_add_u32 s25, s25, 49152
  v_xor_b32 v4, 0, v21
  v_add_u32 v4, s25, v4
  v_xor_b32 v5, 32, v21
  v_add_u32 v5, s25, v5
  v_xor_b32 v6, 64, v21
  v_add_u32 v6, s25, v6
  v_xor_b32 v7, 96, v21
  v_add_u32 v7, s25, v7
  v_lshlrev_b32 v20, 7, v20
  v_lshl_add_u32 v20, v19, 3, v20
  v_lshrrev_b32 v21, 1, v18
  v_xor_b32 v21, s24, v21
  v_lshl_add_u32 v20, v21, 6, v20
  v_lshl_add_u32 v20, v16, 5, v20
  v_add_u32 v10, 98304, v20
  v_lshl_add_u32 v20, v16, 13, v20
  v_xor_b32 v21, 32, v20
  v_add_u32 v8, 81920, v20
  v_add_u32 v9, 81920, v21
  v_and_b32 v11, 0x33, v2
  v_bfe_u32 v17, v2, 2, 1
  v_lshl_or_b32 v11, v17, 3, v11
  v_bfe_u32 v17, v2, 3, 1
  v_lshl_or_b32 v11, v17, 2, v11
  v_lshlrev_b32 v11, 4, v11
  s_cmp_lt_u32 s22, 8
  s_cbranch_scc1 K1_KOFF
  v_mul_u32_u24 v11, 66560, v16
  v_lshrrev_b32 v18, 5, v2
  v_lshl_or_b32 v11, v18, 8, v11
  v_and_b32 v18, 15, v2
  v_lshl_or_b32 v11, v18, 4, v11
K1_KOFF:
  v_mov_b32 v40, v3
  v_lshrrev_b32 v43, 5, v2
  v_and_b32 v44, 15, v2
  v_lshlrev_b32 v44, 4, v44
  v_lshl_or_b32 v44, v43, 8, v44
  v_add_u32 v44, 1024, v44
  v_add_u32 v45, 512, v44
  v_and_b32 v43, 31, v2
  v_subrev_u32 v47, 20, v43
  v_cmp_gt_u32 vcc, 8, v47
  v_mov_b32 v46, 2064
  v_mov_b32 v47, 6224
  v_cndmask_b32 v46, v46, v47, vcc
  v_and_b32 v47, 27, v43
  v_cmp_eq_u32 vcc, 16, v47
  v_subrev_u32 v47, 16, v46
  s_nop 0
  v_cndmask_b32 v46, v46, v47, vcc
  v_cmp_gt_u32 vcc, 16, v43
  s_nop 1
  v_cndmask_b32 v41, v46, v44, vcc
  v_cndmask_b32 v42, v46, v45, vcc
  s_lshl_b32 s33, s20, 8
  s_add_u32 s33, s33, 162176
  v_and_b32 v40, 31, v2
  v_lshlrev_b32 v40, 2, v40
  v_add_u32 v40, s33, v40
  s_lshl_b32 s33, s20, 11
  s_add_u32 s33, s33, 147456
  v_add_u32 v43, s33, v3
  s_lshl_b32 s60, s20, 10
  s_add_u32 s60, s60, 155648
  v_add_u32 v44, s60, v3
  ds_write_b128 v44, v[40:43]
  v_mov_b32 v96, 0
  v_mov_b32 v97, 0
  v_mov_b32 v98, 0
  v_mov_b32 v99, 0
  v_mov_b32 v100, 0
  v_mov_b32 v101, 0
  v_mov_b32 v102, 0
  v_mov_b32 v103, 0
  v_mov_b32 v104, 0
  v_mov_b32 v105, 0
  v_mov_b32 v106, 0
  v_mov_b32 v107, 0
  v_mov_b32 v108, 0
  v_mov_b32 v109, 0
  v_mov_b32 v110, 0
  v_mov_b32 v111, 0
  v_mov_b32 v112, 0
  v_mov_b32 v113, 0
  v_mov_b32 v114, 0
  v_mov_b32 v115, 0
  v_mov_b32 v116, 0
  v_mov_b32 v117, 0
  v_mov_b32 v118, 0
  v_mov_b32 v119, 0
  v_mov_b32 v120, 0
  v_mov_b32 v121, 0
  v_mov_b32 v122, 0
  v_mov_b32 v123, 0
  v_mov_b32 v124, 0
  v_mov_b32 v125, 0
  v_mov_b32 v126, 0
  v_mov_b32 v127, 0
  v_mov_b32 v128, 0
  v_mov_b32 v129, 0
  v_mov_b32 v130, 0
  v_mov_b32 v131, 0
  v_mov_b32 v132, 0
  v_mov_b32 v133, 0
  v_mov_b32 v134, 0
  v_mov_b32 v135, 0
  v_mov_b32 v136, 0
  v_mov_b32 v137, 0
  v_mov_b32 v138, 0
  v_mov_b32 v139, 0
  v_mov_b32 v140, 0
  v_mov_b32 v141, 0
  v_mov_b32 v142, 0
  v_mov_b32 v143, 0
  v_mov_b32 v144, 0
  v_mov_b32 v145, 0
  v_mov_b32 v146, 0
  v_mov_b32 v147, 0
  v_mov_b32 v148, 0
  v_mov_b32 v149, 0
  v_mov_b32 v150, 0
  v_mov_b32 v151, 0
  v_mov_b32 v152, 0
  v_mov_b32 v153, 0
  v_mov_b32 v154, 0
  v_mov_b32 v155, 0
  v_mov_b32 v156, 0
  v_mov_b32 v157, 0
  v_mov_b32 v158, 0
  v_mov_b32 v159, 0
  v_mov_b32 v160, 0
  v_mov_b32 v161, 0
  v_mov_b32 v162, 0
  v_mov_b32 v163, 0
  v_mov_b32 v164, 0
  v_mov_b32 v165, 0
  v_mov_b32 v166, 0
  v_mov_b32 v167, 0
  v_mov_b32 v168, 0
  v_mov_b32 v169, 0
  v_mov_b32 v170, 0
  v_mov_b32 v171, 0
  v_mov_b32 v172, 0
  v_mov_b32 v173, 0
  v_mov_b32 v174, 0
  v_mov_b32 v175, 0
  v_mov_b32 v176, 0
  v_mov_b32 v177, 0
  v_mov_b32 v178, 0
  v_mov_b32 v179, 0
  v_mov_b32 v180, 0
  v_mov_b32 v181, 0
  v_mov_b32 v182, 0
  v_mov_b32 v183, 0
  v_mov_b32 v184, 0
  v_mov_b32 v185, 0
  v_mov_b32 v186, 0
  v_mov_b32 v187, 0
  v_mov_b32 v188, 0
  v_mov_b32 v189, 0
  v_mov_b32 v190, 0
  v_mov_b32 v191, 0
  v_mov_b32 v192, 0
  v_mov_b32 v193, 0
  v_mov_b32 v194, 0
  v_mov_b32 v195, 0
  v_mov_b32 v196, 0
  v_mov_b32 v197, 0
  v_mov_b32 v198, 0
  v_mov_b32 v199, 0
  v_mov_b32 v200, 0
  v_mov_b32 v201, 0
  v_mov_b32 v202, 0
  v_mov_b32 v203, 0
  v_mov_b32 v204, 0
  v_mov_b32 v205, 0
  v_mov_b32 v206, 0
  v_mov_b32 v207, 0
  v_mov_b32 v208, 0
  v_mov_b32 v209, 0
  v_mov_b32 v210, 0
  v_mov_b32 v211, 0
  v_mov_b32 v212, 0
  v_mov_b32 v213, 0
  v_mov_b32 v214, 0
  v_mov_b32 v215, 0
  v_mov_b32 v216, 0
  v_mov_b32 v217, 0
  v_mov_b32 v218, 0
  v_mov_b32 v219, 0
  v_mov_b32 v220, 0
  v_mov_b32 v221, 0
  v_mov_b32 v222, 0
  v_mov_b32 v223, 0
  v_mov_b32 v224, 0
  v_mov_b32 v225, 0
  v_mov_b32 v226, 0
  v_mov_b32 v227, 0
  v_mov_b32 v228, 0
  v_mov_b32 v229, 0
  v_mov_b32 v230, 0
  v_mov_b32 v231, 0
  v_mov_b32 v232, 0
  v_mov_b32 v233, 0
  v_mov_b32 v234, 0
  v_mov_b32 v235, 0
  v_mov_b32 v236, 0
  v_mov_b32 v237, 0
  v_mov_b32 v238, 0
  v_mov_b32 v239, 0
  v_mov_b32 v240, 0
  v_mov_b32 v241, 0
  v_mov_b32 v242, 0
  v_mov_b32 v243, 0
  v_mov_b32 v244, 0
  v_mov_b32 v245, 0
  v_mov_b32 v246, 0
  v_mov_b32 v247, 0
  v_mov_b32 v248, 0
  v_mov_b32 v249, 0
  v_mov_b32 v250, 0
  v_mov_b32 v251, 0
  v_mov_b32 v252, 0
  v_mov_b32 v253, 0
  v_mov_b32 v254, 0
  v_mov_b32 v255, 0
  s_waitcnt lgkmcnt(0)
  s_mov_b32 s28, s10
  s_mov_b32 s29, s11
  s_mov_b32 s30, 0x2800000
  s_mov_b32 s31, 0x20000
  v_mov_b32 v21, 0
  s_cmp_lg_u32 s20, 0
  s_cbranch_scc1 TLB_9
  s_mov_b32 s33, 0x10000
  buffer_load_dword v22, v21, s[28:31], s33 offen sc1
  s_mov_b32 s33, 0x207c00
  buffer_load_dword v22, v21, s[28:31], s33 offen sc1
  s_lshl_b32 s33, s72, 16
  s_lshl_b32 s34, s73, 7
  s_add_u32 s33, s33, s34
  v_mov_b32 v20, s33
  global_load_dword v22, v20, s[64:65] sc1
TLB_9:
  s_cmp_lg_u32 s20, 1
  s_cbranch_scc1 TLB_10
  s_mov_b32 s33, 0x407800
  buffer_load_dword v22, v21, s[28:31], s33 offen sc1
  s_mov_b32 s33, 0x607400
  buffer_load_dword v22, v21, s[28:31], s33 offen sc1
  global_load_dword v22, v21, s[16:17]
TLB_10:
  s_cmp_lg_u32 s20, 2
  s_cbranch_scc1 TLB_11
  s_mov_b32 s33, 0x803c00
  buffer_load_dword v22, v21, s[28:31], s33 offen sc1
  s_mov_b32 s33, 0xa00400
  buffer_load_dword v22, v21, s[28:31], s33 offen sc1
  global_load_dword v22, v21, s[8:9]
TLB_11:
  s_cmp_lg_u32 s20, 3
  s_cbranch_scc1 TLB_12
  s_mov_b32 s33, 0xc19000
  buffer_load_dword v22, v21, s[28:31], s33 offen sc1
  s_mov_b32 s33, 0xf60000
  buffer_load_dword v22, v21, s[28:31], s33 offen sc1
  global_load_dword v22, v21, s[18:19]
TLB_12:
  s_getpc_b64 s[50:51]
PC_HERE:
  s_sub_u32 s50, s50, PC_HERE-gated_mix__softmax_full_mha__geglu_ffn__prompt_kernel
  s_subb_u32 s51, s51, 0
  s_lshr_b32 s49, s2, 3
  s_lshl_b32 s49, s49, 2
  s_add_u32 s49, s49, s20
  s_lshl_b32 s49, s49, 9
  v_lshlrev_b32 v21, 3, v2
  v_add_u32 v21, s49, v21
  v_min_u32 v21, K_END-gated_mix__softmax_full_mha__geglu_ffn__prompt_kernel-4, v21
  global_load_dword v21, v21, s[50:51]
  s_lshl_b32 s32, s21, 2
  s_lshl_b32 s33, s23, 1
  s_add_u32 s32, s32, s33
  s_and_b32 s36, s22, 7
  s_lshl_b32 s36, s36, 2
  s_lshl_b32 s37, s24, 1
  s_add_u32 s36, s36, s37
  s_mul_i32 s36, s36, 65
  s_add_u32 s36, s36, s32
  s_lshl_b32 s36, s36, 10
  s_cmp_lt_u32 s22, 8
  s_mov_b32 s38, 2162688
  s_cselect_b32 s38, 0, s38
  s_movk_i32 s37, 512
  s_cselect_b32 s37, 66560, s37
  s_add_u32 s36, s36, s38
  s_add_u32 s37, s37, s36
  s_mov_b32 s25, 0
  s_mov_b32 s61, 0xeff31ef
  s_mov_b32 s26, 8
  s_barrier
  ds_read_b128 v[24:27], v4
  ds_read_b64_tr_b16 v[32:33], v8 offset:0
  ds_read_b64_tr_b16 v[34:35], v8 offset:512
  ds_read_b128 v[28:31], v4 offset:4096
  ds_read_b64_tr_b16 v[36:37], v9 offset:0
  ds_read_b64_tr_b16 v[38:39], v9 offset:512
  ds_read_b64_tr_b16 v[40:41], v10 offset:0
  ds_read_b64_tr_b16 v[42:43], v10 offset:512
  s_cmp_lt_u32 s22, 8
  s_cbranch_scc0 SW1V
.p2align 6
SW1K:
  s_waitcnt lgkmcnt(4)
  v_mfma_f32_32x32x16_bf16 v[96:111], v[32:35], v[24:27], v[96:111]
  ds_read_b128 v[44:47], v5
  ds_read_b64_tr_b16 v[52:53], v8 offset:2048
  v_mfma_f32_32x32x16_bf16 v[128:143], v[32:35], v[28:31], v[128:143]
  ds_read_b64_tr_b16 v[54:55], v8 offset:2560
  ds_read_b128 v[48:51], v5 offset:4096
  s_waitcnt lgkmcnt(4)
  v_mfma_f32_32x32x16_bf16 v[112:127], v[36:39], v[24:27], v[112:127]
  ds_read_b64_tr_b16 v[56:57], v9 offset:2048
  ds_read_b64_tr_b16 v[58:59], v9 offset:2560
  v_mfma_f32_32x32x16_bf16 v[144:159], v[36:39], v[28:31], v[144:159]
  ds_read_b64_tr_b16 v[60:61], v10 offset:2048
  ds_read_b64_tr_b16 v[62:63], v10 offset:2560
  v_mfma_f32_32x32x16_bf16 v[224:239], v[40:43], v[24:27], v[224:239]
  v_mfma_f32_32x32x16_bf16 v[240:255], v[40:43], v[28:31], v[240:255]
  s_waitcnt lgkmcnt(4)
  v_mfma_f32_32x32x16_bf16 v[96:111], v[52:55], v[44:47], v[96:111]
  ds_read_b128 v[24:27], v6
  ds_read_b64_tr_b16 v[32:33], v8 offset:4096
  v_mfma_f32_32x32x16_bf16 v[128:143], v[52:55], v[48:51], v[128:143]
  ds_read_b64_tr_b16 v[34:35], v8 offset:4608
  ds_read_b128 v[28:31], v6 offset:4096
  s_waitcnt lgkmcnt(4)
  v_mfma_f32_32x32x16_bf16 v[112:127], v[56:59], v[44:47], v[112:127]
  ds_read_b64_tr_b16 v[36:37], v9 offset:4096
  ds_read_b64_tr_b16 v[38:39], v9 offset:4608
  v_mfma_f32_32x32x16_bf16 v[144:159], v[56:59], v[48:51], v[144:159]
  ds_read_b64_tr_b16 v[40:41], v10 offset:4096
  ds_read_b64_tr_b16 v[42:43], v10 offset:4608
  v_mfma_f32_32x32x16_bf16 v[224:239], v[60:63], v[44:47], v[224:239]
  v_mfma_f32_32x32x16_bf16 v[240:255], v[60:63], v[48:51], v[240:255]
  s_waitcnt lgkmcnt(4)
  v_mfma_f32_32x32x16_bf16 v[96:111], v[32:35], v[24:27], v[96:111]
  ds_read_b128 v[44:47], v7
  ds_read_b64_tr_b16 v[52:53], v8 offset:6144
  v_mfma_f32_32x32x16_bf16 v[128:143], v[32:35], v[28:31], v[128:143]
  ds_read_b64_tr_b16 v[54:55], v8 offset:6656
  ds_read_b128 v[48:51], v7 offset:4096
  s_waitcnt lgkmcnt(4)
  v_mfma_f32_32x32x16_bf16 v[112:127], v[36:39], v[24:27], v[112:127]
  ds_read_b64_tr_b16 v[56:57], v9 offset:6144
  ds_read_b64_tr_b16 v[58:59], v9 offset:6656
  v_mfma_f32_32x32x16_bf16 v[144:159], v[36:39], v[28:31], v[144:159]
  ds_read_b64_tr_b16 v[60:61], v10 offset:6144
  ds_read_b64_tr_b16 v[62:63], v10 offset:6656
  v_mfma_f32_32x32x16_bf16 v[224:239], v[40:43], v[24:27], v[224:239]
  s_add_u32 s25, s25, 1
  s_cmp_eq_u32 s25, 3
  s_mov_b32 s27, 24576
  s_cselect_b32 s27, 0xffff4000, s27
  s_cselect_b32 s25, 0, s25
  s_bfe_i32 s33, s61, 0x40000
  s_lshr_b32 s61, s61, 4
  s_lshl_b32 s33, s33, 14
  v_add_u32 v8, s27, v8
  v_add_u32 v9, s27, v9
  v_mfma_f32_32x32x16_bf16 v[240:255], v[40:43], v[28:31], v[240:255]
  v_add_u32 v10, s27, v10
  v_add_u32 v4, s33, v4
  v_add_u32 v5, s33, v5
  v_add_u32 v6, s33, v6
  v_add_u32 v7, s33, v7
  s_waitcnt lgkmcnt(4)
  v_mfma_f32_32x32x16_bf16 v[96:111], v[52:55], v[44:47], v[96:111]
  s_waitcnt lgkmcnt(0)
  s_barrier
  ds_read_b128 v[24:27], v4
  v_mfma_f32_32x32x16_bf16 v[128:143], v[52:55], v[48:51], v[128:143]
  ds_read_b64_tr_b16 v[32:33], v8 offset:0
  ds_read_b64_tr_b16 v[34:35], v8 offset:512
  ds_read_b128 v[28:31], v4 offset:4096
  v_mfma_f32_32x32x16_bf16 v[112:127], v[56:59], v[44:47], v[112:127]
  ds_read_b64_tr_b16 v[36:37], v9 offset:0
  ds_read_b64_tr_b16 v[38:39], v9 offset:512
  v_mfma_f32_32x32x16_bf16 v[144:159], v[56:59], v[48:51], v[144:159]
  ds_read_b64_tr_b16 v[40:41], v10 offset:0
  ds_read_b64_tr_b16 v[42:43], v10 offset:512
  v_mfma_f32_32x32x16_bf16 v[224:239], v[60:63], v[44:47], v[224:239]
  s_sub_u32 s26, s26, 1
  s_cmp_lg_u32 s26, 0
  v_mfma_f32_32x32x16_bf16 v[240:255], v[60:63], v[48:51], v[240:255]
  s_cbranch_scc1 SW1K
  s_branch K1_KVEPI
.p2align 6
SW1V:
  s_waitcnt lgkmcnt(4)
  v_mfma_f32_32x32x16_bf16 v[96:111], v[32:35], v[24:27], v[96:111]
  ds_read_b128 v[44:47], v5
  ds_read_b64_tr_b16 v[52:53], v8 offset:2048
  v_mfma_f32_32x32x16_bf16 v[128:143], v[32:35], v[28:31], v[128:143]
  ds_read_b64_tr_b16 v[54:55], v8 offset:2560
  ds_read_b128 v[48:51], v5 offset:4096
  s_waitcnt lgkmcnt(4)
  v_mfma_f32_32x32x16_bf16 v[112:127], v[36:39], v[24:27], v[112:127]
  ds_read_b64_tr_b16 v[56:57], v9 offset:2048
  ds_read_b64_tr_b16 v[58:59], v9 offset:2560
  v_mfma_f32_32x32x16_bf16 v[144:159], v[36:39], v[28:31], v[144:159]
  ds_read_b64_tr_b16 v[60:61], v10 offset:2048
  ds_read_b64_tr_b16 v[62:63], v10 offset:2560
  v_mfma_f32_32x32x16_bf16 v[224:239], v[24:27], v[40:43], v[224:239]
  v_mfma_f32_32x32x16_bf16 v[240:255], v[28:31], v[40:43], v[240:255]
  s_waitcnt lgkmcnt(4)
  v_mfma_f32_32x32x16_bf16 v[96:111], v[52:55], v[44:47], v[96:111]
  ds_read_b128 v[24:27], v6
  ds_read_b64_tr_b16 v[32:33], v8 offset:4096
  v_mfma_f32_32x32x16_bf16 v[128:143], v[52:55], v[48:51], v[128:143]
  ds_read_b64_tr_b16 v[34:35], v8 offset:4608
  ds_read_b128 v[28:31], v6 offset:4096
  s_waitcnt lgkmcnt(4)
  v_mfma_f32_32x32x16_bf16 v[112:127], v[56:59], v[44:47], v[112:127]
  ds_read_b64_tr_b16 v[36:37], v9 offset:4096
  ds_read_b64_tr_b16 v[38:39], v9 offset:4608
  v_mfma_f32_32x32x16_bf16 v[144:159], v[56:59], v[48:51], v[144:159]
  ds_read_b64_tr_b16 v[40:41], v10 offset:4096
  ds_read_b64_tr_b16 v[42:43], v10 offset:4608
  v_mfma_f32_32x32x16_bf16 v[224:239], v[44:47], v[60:63], v[224:239]
  v_mfma_f32_32x32x16_bf16 v[240:255], v[48:51], v[60:63], v[240:255]
  s_waitcnt lgkmcnt(4)
  v_mfma_f32_32x32x16_bf16 v[96:111], v[32:35], v[24:27], v[96:111]
  ds_read_b128 v[44:47], v7
  ds_read_b64_tr_b16 v[52:53], v8 offset:6144
  v_mfma_f32_32x32x16_bf16 v[128:143], v[32:35], v[28:31], v[128:143]
  ds_read_b64_tr_b16 v[54:55], v8 offset:6656
  ds_read_b128 v[48:51], v7 offset:4096
  s_waitcnt lgkmcnt(4)
  v_mfma_f32_32x32x16_bf16 v[112:127], v[36:39], v[24:27], v[112:127]
  ds_read_b64_tr_b16 v[56:57], v9 offset:6144
  ds_read_b64_tr_b16 v[58:59], v9 offset:6656
  v_mfma_f32_32x32x16_bf16 v[144:159], v[36:39], v[28:31], v[144:159]
  ds_read_b64_tr_b16 v[60:61], v10 offset:6144
  ds_read_b64_tr_b16 v[62:63], v10 offset:6656
  v_mfma_f32_32x32x16_bf16 v[224:239], v[24:27], v[40:43], v[224:239]
  s_add_u32 s25, s25, 1
  s_cmp_eq_u32 s25, 3
  s_mov_b32 s27, 24576
  s_cselect_b32 s27, 0xffff4000, s27
  s_cselect_b32 s25, 0, s25
  s_bfe_i32 s33, s61, 0x40000
  s_lshr_b32 s61, s61, 4
  s_lshl_b32 s33, s33, 14
  v_add_u32 v8, s27, v8
  v_add_u32 v9, s27, v9
  v_mfma_f32_32x32x16_bf16 v[240:255], v[28:31], v[40:43], v[240:255]
  v_add_u32 v10, s27, v10
  v_add_u32 v4, s33, v4
  v_add_u32 v5, s33, v5
  v_add_u32 v6, s33, v6
  v_add_u32 v7, s33, v7
  s_waitcnt lgkmcnt(4)
  v_mfma_f32_32x32x16_bf16 v[96:111], v[52:55], v[44:47], v[96:111]
  s_waitcnt lgkmcnt(0)
  s_barrier
  ds_read_b128 v[24:27], v4
  v_mfma_f32_32x32x16_bf16 v[128:143], v[52:55], v[48:51], v[128:143]
  ds_read_b64_tr_b16 v[32:33], v8 offset:0
  ds_read_b64_tr_b16 v[34:35], v8 offset:512
  ds_read_b128 v[28:31], v4 offset:4096
  v_mfma_f32_32x32x16_bf16 v[112:127], v[56:59], v[44:47], v[112:127]
  ds_read_b64_tr_b16 v[36:37], v9 offset:0
  ds_read_b64_tr_b16 v[38:39], v9 offset:512
  v_mfma_f32_32x32x16_bf16 v[144:159], v[56:59], v[48:51], v[144:159]
  ds_read_b64_tr_b16 v[40:41], v10 offset:0
  ds_read_b64_tr_b16 v[42:43], v10 offset:512
  v_mfma_f32_32x32x16_bf16 v[224:239], v[44:47], v[60:63], v[224:239]
  s_sub_u32 s26, s26, 1
  s_cmp_lg_u32 s26, 0
  v_mfma_f32_32x32x16_bf16 v[240:255], v[48:51], v[60:63], v[240:255]
  s_cbranch_scc1 SW1V
K1_KVEPI:
  s_waitcnt vmcnt(0)
  v_mov_b32 v0, 163608
  v_mov_b32 v1, 1
  v_mov_b32 v16, 163584
  ds_read_b64 v[18:19], v16
  v_mov_b32 v12, 0xc0135761
  v_mov_b32 v13, v12
  v_mov_b32 v14, 1.0
  v_mov_b32 v15, 1.0
  s_waitcnt lgkmcnt(0)
  v_readfirstlane_b32 s68, v18
  v_readfirstlane_b32 s69, v19
  s_cmp_lt_u32 s22, 12
  s_cbranch_scc1 SW2R
  s_mov_b32 s34, 0x3eb8aa3b
  s_sub_u32 s38, s22, 12
  s_lshl_b32 s38, s38, 3
  s_lshl_b32 s39, s24, 1
  s_add_u32 s38, s38, s39
  s_mul_i32 s38, s38, 65
  s_add_u32 s38, s38, s32
  s_lshl_b32 s38, s38, 10
  s_waitcnt lgkmcnt(2)
  v_mfma_f32_32x32x16_bf16 v[160:175], v[32:35], v[24:27], v[160:175]
  ds_read_b128 v[44:47], v5
  ds_read_b64_tr_b16 v[52:53], v8 offset:2048
  v_mfma_f32_32x32x16_bf16 v[192:207], v[32:35], v[28:31], v[192:207]
  ds_read_b64_tr_b16 v[54:55], v8 offset:2560
  ds_read_b128 v[48:51], v5 offset:4096
  s_waitcnt lgkmcnt(4)
  v_mfma_f32_32x32x16_bf16 v[176:191], v[36:39], v[24:27], v[176:191]
  ds_read_b64_tr_b16 v[56:57], v9 offset:2048
  ds_read_b64_tr_b16 v[58:59], v9 offset:2560
  v_mfma_f32_32x32x16_bf16 v[208:223], v[36:39], v[28:31], v[208:223]
  v_add_u32 v5, 0x8000, v5
  v_add_u32 v4, 0x8000, v4
  s_waitcnt lgkmcnt(2)
  v_mfma_f32_32x32x16_bf16 v[160:175], v[52:55], v[44:47], v[160:175]
  ds_read_b128 v[24:27], v6
  ds_read_b64_tr_b16 v[32:33], v8 offset:4096
  v_cvt_pk_bf16_f32 v64, v224, v225
  v_cvt_pk_bf16_f32 v65, v226, v227
  v_cvt_pk_bf16_f32 v66, v228, v229
  v_cvt_pk_bf16_f32 v67, v230, v231
  buffer_store_dwordx4 v[64:67], v11, s[28:31], s36 offen offset:0 sc1
  v_cvt_pk_bf16_f32 v68, v232, v233
  v_cvt_pk_bf16_f32 v69, v234, v235
  v_cvt_pk_bf16_f32 v70, v236, v237
  v_mfma_f32_32x32x16_bf16 v[192:207], v[52:55], v[48:51], v[192:207]
  ds_read_b64_tr_b16 v[34:35], v8 offset:4608
  ds_read_b128 v[28:31], v6 offset:4096
  v_cvt_pk_bf16_f32 v71, v238, v239
  buffer_store_dwordx4 v[68:71], v11, s[28:31], s37 offen offset:0 sc1
  v_cvt_pk_bf16_f32 v72, v240, v241
  v_cvt_pk_bf16_f32 v73, v242, v243
  v_cvt_pk_bf16_f32 v74, v244, v245
  v_cvt_pk_bf16_f32 v75, v246, v247
  buffer_store_dwordx4 v[72:75], v11, s[28:31], s36 offen offset:1024 sc1
  v_cvt_pk_bf16_f32 v76, v248, v249
  s_waitcnt lgkmcnt(4)
  v_mfma_f32_32x32x16_bf16 v[176:191], v[56:59], v[44:47], v[176:191]
  ds_read_b64_tr_b16 v[36:37], v9 offset:4096
  ds_read_b64_tr_b16 v[38:39], v9 offset:4608
  v_cvt_pk_bf16_f32 v77, v250, v251
  v_cvt_pk_bf16_f32 v78, v252, v253
  v_cvt_pk_bf16_f32 v79, v254, v255
  buffer_store_dwordx4 v[76:79], v11, s[28:31], s37 offen offset:1024 sc1
  v_mul_f32 v96, s34, v96
  v_mul_f32 v97, s34, v97
  v_mul_f32 v98, s34, v98
  v_mul_f32 v99, s34, v99
  v_mfma_f32_32x32x16_bf16 v[208:223], v[56:59], v[48:51], v[208:223]
  v_add_u32 v6, 0x8000, v6
  v_mul_f32 v100, s34, v100
  v_mul_f32 v101, s34, v101
  v_mul_f32 v102, s34, v102
  v_mul_f32 v103, s34, v103
  v_cvt_pk_bf16_f32 v96, v96, v97
  v_cvt_pk_bf16_f32 v97, v98, v99
  v_cvt_pk_bf16_f32 v98, v100, v101
  v_cvt_pk_bf16_f32 v99, v102, v103
  s_add_u32 s39, s38, 4325376
  buffer_store_dwordx4 v[96:99], v3, s[28:31], s39 offen offset:0 sc1
  s_waitcnt lgkmcnt(2)
  v_mfma_f32_32x32x16_bf16 v[160:175], v[32:35], v[24:27], v[160:175]
  ds_read_b128 v[44:47], v7
  ds_read_b64_tr_b16 v[52:53], v8 offset:6144
  v_mul_f32 v104, s34, v104
  v_mul_f32 v105, s34, v105
  v_mul_f32 v106, s34, v106
  v_mul_f32 v107, s34, v107
  v_mul_f32 v108, s34, v108
  v_mul_f32 v109, s34, v109
  v_mul_f32 v110, s34, v110
  v_mul_f32 v111, s34, v111
  v_mfma_f32_32x32x16_bf16 v[192:207], v[32:35], v[28:31], v[192:207]
  ds_read_b64_tr_b16 v[54:55], v8 offset:6656
  ds_read_b128 v[48:51], v7 offset:4096
  v_cvt_pk_bf16_f32 v104, v104, v105
  v_cvt_pk_bf16_f32 v105, v106, v107
  v_cvt_pk_bf16_f32 v106, v108, v109
  v_cvt_pk_bf16_f32 v107, v110, v111
  s_add_u32 s39, s38, 4591616
  buffer_store_dwordx4 v[104:107], v3, s[28:31], s39 offen offset:0 sc1
  v_mul_f32 v128, s34, v128
  v_mul_f32 v129, s34, v129
  v_mul_f32 v130, s34, v130
  s_waitcnt lgkmcnt(4)
  v_mfma_f32_32x32x16_bf16 v[176:191], v[36:39], v[24:27], v[176:191]
  ds_read_b64_tr_b16 v[56:57], v9 offset:6144
  ds_read_b64_tr_b16 v[58:59], v9 offset:6656
  v_mul_f32 v131, s34, v131
  v_mul_f32 v132, s34, v132
  v_mul_f32 v133, s34, v133
  v_mul_f32 v134, s34, v134
  v_mul_f32 v135, s34, v135
  v_cvt_pk_bf16_f32 v128, v128, v129
  v_cvt_pk_bf16_f32 v129, v130, v131
  v_cvt_pk_bf16_f32 v130, v132, v133
  v_mfma_f32_32x32x16_bf16 v[208:223], v[36:39], v[28:31], v[208:223]
  v_add_u32 v7, 0x8000, v7
  v_add_u32 v8, 0xffff4000, v8
  v_add_u32 v9, 0xffff4000, v9
  v_cvt_pk_bf16_f32 v131, v134, v135
  s_add_u32 s39, s38, 4325376
  buffer_store_dwordx4 v[128:131], v3, s[28:31], s39 offen offset:1024 sc1
  v_mul_f32 v136, s34, v136
  v_mul_f32 v137, s34, v137
  v_mul_f32 v138, s34, v138
  v_mul_f32 v139, s34, v139
  v_mul_f32 v140, s34, v140
  s_waitcnt lgkmcnt(2)
  v_mfma_f32_32x32x16_bf16 v[160:175], v[52:55], v[44:47], v[160:175]
  v_mul_f32 v141, s34, v141
  v_mul_f32 v142, s34, v142
  v_mul_f32 v143, s34, v143
  v_cvt_pk_bf16_f32 v136, v136, v137
  v_cvt_pk_bf16_f32 v137, v138, v139
  v_cvt_pk_bf16_f32 v138, v140, v141
  v_cvt_pk_bf16_f32 v139, v142, v143
  s_add_u32 s39, s38, 4591616
  buffer_store_dwordx4 v[136:139], v3, s[28:31], s39 offen offset:1024 sc1
  v_mul_f32 v112, s34, v112
  s_waitcnt lgkmcnt(0)
  s_barrier
  ds_read_b128 v[24:27], v4
  v_mfma_f32_32x32x16_bf16 v[192:207], v[52:55], v[48:51], v[192:207]
  ds_read_b64_tr_b16 v[32:33], v8 offset:0
  ds_read_b64_tr_b16 v[34:35], v8 offset:512
  ds_read_b128 v[28:31], v4 offset:4096
  v_mul_f32 v113, s34, v113
  v_mul_f32 v114, s34, v114
  v_mul_f32 v115, s34, v115
  v_mul_f32 v116, s34, v116
  v_mul_f32 v117, s34, v117
  v_mul_f32 v118, s34, v118
  v_mul_f32 v119, s34, v119
  v_mfma_f32_32x32x16_bf16 v[176:191], v[56:59], v[44:47], v[176:191]
  ds_read_b64_tr_b16 v[36:37], v9 offset:0
  ds_read_b64_tr_b16 v[38:39], v9 offset:512
  v_cvt_pk_bf16_f32 v112, v112, v113
  v_cvt_pk_bf16_f32 v113, v114, v115
  v_cvt_pk_bf16_f32 v114, v116, v117
  v_cvt_pk_bf16_f32 v115, v118, v119
  s_add_u32 s39, s38, 4391936
  buffer_store_dwordx4 v[112:115], v3, s[28:31], s39 offen offset:0 sc1
  v_mul_f32 v120, s34, v120
  v_mul_f32 v121, s34, v121
  v_mul_f32 v122, s34, v122
  v_mfma_f32_32x32x16_bf16 v[208:223], v[56:59], v[48:51], v[208:223]
  v_mul_f32 v123, s34, v123
  v_mul_f32 v124, s34, v124
  v_mul_f32 v125, s34, v125
  v_mul_f32 v126, s34, v126
  v_mul_f32 v127, s34, v127
  v_cvt_pk_bf16_f32 v120, v120, v121
  v_cvt_pk_bf16_f32 v121, v122, v123
  v_cvt_pk_bf16_f32 v122, v124, v125
  v_cvt_pk_bf16_f32 v123, v126, v127
  s_add_u32 s39, s38, 4658176
  buffer_store_dwordx4 v[120:123], v3, s[28:31], s39 offen offset:0 sc1
  s_waitcnt lgkmcnt(2)
  v_mfma_f32_32x32x16_bf16 v[160:175], v[32:35], v[24:27], v[160:175]
  ds_read_b128 v[44:47], v5
  ds_read_b64_tr_b16 v[52:53], v8 offset:2048
  v_mul_f32 v144, s34, v144
  v_mul_f32 v145, s34, v145
  v_mul_f32 v146, s34, v146
  v_mul_f32 v147, s34, v147
  v_mul_f32 v148, s34, v148
  v_mul_f32 v149, s34, v149
  v_mul_f32 v150, s34, v150
  v_mul_f32 v151, s34, v151
  v_mfma_f32_32x32x16_bf16 v[192:207], v[32:35], v[28:31], v[192:207]
  ds_read_b64_tr_b16 v[54:55], v8 offset:2560
  ds_read_b128 v[48:51], v5 offset:4096
  v_cvt_pk_bf16_f32 v144, v144, v145
  v_cvt_pk_bf16_f32 v145, v146, v147
  v_cvt_pk_bf16_f32 v146, v148, v149
  v_cvt_pk_bf16_f32 v147, v150, v151
  s_add_u32 s39, s38, 4391936
  buffer_store_dwordx4 v[144:147], v3, s[28:31], s39 offen offset:1024 sc1
  v_mul_f32 v152, s34, v152
  v_mul_f32 v153, s34, v153
  v_mul_f32 v154, s34, v154
  s_waitcnt lgkmcnt(4)
  v_mfma_f32_32x32x16_bf16 v[176:191], v[36:39], v[24:27], v[176:191]
  ds_read_b64_tr_b16 v[56:57], v9 offset:2048
  ds_read_b64_tr_b16 v[58:59], v9 offset:2560
  v_mul_f32 v155, s34, v155
  v_mul_f32 v156, s34, v156
  v_mul_f32 v157, s34, v157
  v_mul_f32 v158, s34, v158
  v_mul_f32 v159, s34, v159
  v_cvt_pk_bf16_f32 v152, v152, v153
  v_cvt_pk_bf16_f32 v153, v154, v155
  v_cvt_pk_bf16_f32 v154, v156, v157
  v_mfma_f32_32x32x16_bf16 v[208:223], v[36:39], v[28:31], v[208:223]
  v_add_u32 v5, 0x4000, v5
  v_add_u32 v4, 0x4000, v4
  v_cvt_pk_bf16_f32 v155, v158, v159
  s_add_u32 s39, s38, 4658176
  buffer_store_dwordx4 v[152:155], v3, s[28:31], s39 offen offset:1024 sc1
  s_waitcnt lgkmcnt(2)
  v_mfma_f32_32x32x16_bf16 v[160:175], v[52:55], v[44:47], v[160:175]
  ds_read_b128 v[24:27], v6
  ds_read_b64_tr_b16 v[32:33], v8 offset:4096
  v_mfma_f32_32x32x16_bf16 v[192:207], v[52:55], v[48:51], v[192:207]
  ds_read_b64_tr_b16 v[34:35], v8 offset:4608
  ds_read_b128 v[28:31], v6 offset:4096
  s_waitcnt lgkmcnt(4)
  v_mfma_f32_32x32x16_bf16 v[176:191], v[56:59], v[44:47], v[176:191]
  ds_read_b64_tr_b16 v[36:37], v9 offset:4096
  ds_read_b64_tr_b16 v[38:39], v9 offset:4608
  v_mfma_f32_32x32x16_bf16 v[208:223], v[56:59], v[48:51], v[208:223]
  v_add_u32 v6, 0x4000, v6
  s_waitcnt lgkmcnt(2)
  v_mfma_f32_32x32x16_bf16 v[160:175], v[32:35], v[24:27], v[160:175]
  ds_read_b128 v[44:47], v7
  ds_read_b64_tr_b16 v[52:53], v8 offset:6144
  v_mfma_f32_32x32x16_bf16 v[192:207], v[32:35], v[28:31], v[192:207]
  ds_read_b64_tr_b16 v[54:55], v8 offset:6656
  ds_read_b128 v[48:51], v7 offset:4096
  s_waitcnt lgkmcnt(4)
  v_mfma_f32_32x32x16_bf16 v[176:191], v[36:39], v[24:27], v[176:191]
  ds_read_b64_tr_b16 v[56:57], v9 offset:6144
  ds_read_b64_tr_b16 v[58:59], v9 offset:6656
  v_mfma_f32_32x32x16_bf16 v[208:223], v[36:39], v[28:31], v[208:223]
  v_add_u32 v7, 0x4000, v7
  v_add_u32 v8, 0x4000, v8
  v_add_u32 v9, 0x4000, v9
  s_waitcnt lgkmcnt(2)
  v_mfma_f32_32x32x16_bf16 v[160:175], v[52:55], v[44:47], v[160:175]
  s_waitcnt vmcnt(8)
  s_waitcnt lgkmcnt(0)
  s_barrier
  ds_read_b128 v[24:27], v4
  v_mfma_f32_32x32x16_bf16 v[192:207], v[52:55], v[48:51], v[192:207]
  ds_read_b64_tr_b16 v[32:33], v8 offset:0
  ds_read_b64_tr_b16 v[34:35], v8 offset:512
  ds_read_b128 v[28:31], v4 offset:4096
  v_mfma_f32_32x32x16_bf16 v[176:191], v[56:59], v[44:47], v[176:191]
  ds_read_b64_tr_b16 v[36:37], v9 offset:0
  ds_read_b64_tr_b16 v[38:39], v9 offset:512
  v_mfma_f32_32x32x16_bf16 v[208:223], v[56:59], v[48:51], v[208:223]
  s_waitcnt lgkmcnt(2)
  v_mfma_f32_32x32x16_bf16 v[160:175], v[32:35], v[24:27], v[160:175]
  ds_read_b128 v[44:47], v5
  ds_read_b64_tr_b16 v[52:53], v8 offset:2048
  v_mfma_f32_32x32x16_bf16 v[192:207], v[32:35], v[28:31], v[192:207]
  ds_read_b64_tr_b16 v[54:55], v8 offset:2560
  ds_read_b128 v[48:51], v5 offset:4096
  s_waitcnt lgkmcnt(4)
  v_mfma_f32_32x32x16_bf16 v[176:191], v[36:39], v[24:27], v[176:191]
  ds_read_b64_tr_b16 v[56:57], v9 offset:2048
  ds_read_b64_tr_b16 v[58:59], v9 offset:2560
  v_mfma_f32_32x32x16_bf16 v[208:223], v[36:39], v[28:31], v[208:223]
  v_add_u32 v5, 0x4000, v5
  v_add_u32 v4, 0x4000, v4
  s_waitcnt lgkmcnt(2)
  v_mfma_f32_32x32x16_bf16 v[160:175], v[52:55], v[44:47], v[160:175]
  ds_read_b128 v[24:27], v6
  ds_read_b64_tr_b16 v[32:33], v8 offset:4096
  v_mfma_f32_32x32x16_bf16 v[192:207], v[52:55], v[48:51], v[192:207]
  ds_read_b64_tr_b16 v[34:35], v8 offset:4608
  ds_read_b128 v[28:31], v6 offset:4096
  s_waitcnt lgkmcnt(4)
  v_mfma_f32_32x32x16_bf16 v[176:191], v[56:59], v[44:47], v[176:191]
  ds_read_b64_tr_b16 v[36:37], v9 offset:4096
  ds_read_b64_tr_b16 v[38:39], v9 offset:4608
  v_mfma_f32_32x32x16_bf16 v[208:223], v[56:59], v[48:51], v[208:223]
  v_add_u32 v6, 0x4000, v6
  s_waitcnt lgkmcnt(2)
  v_mfma_f32_32x32x16_bf16 v[160:175], v[32:35], v[24:27], v[160:175]
  ds_read_b128 v[44:47], v7
  ds_read_b64_tr_b16 v[52:53], v8 offset:6144
  v_mfma_f32_32x32x16_bf16 v[192:207], v[32:35], v[28:31], v[192:207]
  ds_read_b64_tr_b16 v[54:55], v8 offset:6656
  ds_read_b128 v[48:51], v7 offset:4096
  s_waitcnt lgkmcnt(4)
  v_mfma_f32_32x32x16_bf16 v[176:191], v[36:39], v[24:27], v[176:191]
  ds_read_b64_tr_b16 v[56:57], v9 offset:6144
  ds_read_b64_tr_b16 v[58:59], v9 offset:6656
  v_mfma_f32_32x32x16_bf16 v[208:223], v[36:39], v[28:31], v[208:223]
  v_add_u32 v7, 0x4000, v7
  v_add_u32 v8, 0x4000, v8
  v_add_u32 v9, 0x4000, v9
  s_waitcnt lgkmcnt(2)
  v_mfma_f32_32x32x16_bf16 v[160:175], v[52:55], v[44:47], v[160:175]
  s_waitcnt vmcnt(0)
  s_waitcnt lgkmcnt(0)
  s_barrier
  ds_read_b128 v[24:27], v4
  v_mfma_f32_32x32x16_bf16 v[192:207], v[52:55], v[48:51], v[192:207]
  ds_read_b64_tr_b16 v[32:33], v8 offset:0
  ds_read_b64_tr_b16 v[34:35], v8 offset:512
  ds_read_b128 v[28:31], v4 offset:4096
  v_mfma_f32_32x32x16_bf16 v[176:191], v[56:59], v[44:47], v[176:191]
  ds_read_b64_tr_b16 v[36:37], v9 offset:0
  ds_read_b64_tr_b16 v[38:39], v9 offset:512
  v_mfma_f32_32x32x16_bf16 v[208:223], v[56:59], v[48:51], v[208:223]
  s_waitcnt lgkmcnt(2)
  v_mfma_f32_32x32x16_bf16 v[160:175], v[32:35], v[24:27], v[160:175]
  ds_read_b128 v[44:47], v5
  ds_read_b64_tr_b16 v[52:53], v8 offset:2048
  v_mfma_f32_32x32x16_bf16 v[192:207], v[32:35], v[28:31], v[192:207]
  ds_read_b64_tr_b16 v[54:55], v8 offset:2560
  ds_read_b128 v[48:51], v5 offset:4096
  s_waitcnt lgkmcnt(4)
  v_mfma_f32_32x32x16_bf16 v[176:191], v[36:39], v[24:27], v[176:191]
  ds_read_b64_tr_b16 v[56:57], v9 offset:2048
  ds_read_b64_tr_b16 v[58:59], v9 offset:2560
  v_mfma_f32_32x32x16_bf16 v[208:223], v[36:39], v[28:31], v[208:223]
  v_add_u32 v5, 0xffff4000, v5
  v_add_u32 v4, 0xffff4000, v4
  s_waitcnt lgkmcnt(2)
  v_mfma_f32_32x32x16_bf16 v[160:175], v[52:55], v[44:47], v[160:175]
  ds_read_b128 v[24:27], v6
  ds_read_b64_tr_b16 v[32:33], v8 offset:4096
  v_mfma_f32_32x32x16_bf16 v[192:207], v[52:55], v[48:51], v[192:207]
  ds_read_b64_tr_b16 v[34:35], v8 offset:4608
  ds_read_b128 v[28:31], v6 offset:4096
  s_waitcnt lgkmcnt(4)
  v_mfma_f32_32x32x16_bf16 v[176:191], v[56:59], v[44:47], v[176:191]
  ds_read_b64_tr_b16 v[36:37], v9 offset:4096
  ds_read_b64_tr_b16 v[38:39], v9 offset:4608
  v_mfma_f32_32x32x16_bf16 v[208:223], v[56:59], v[48:51], v[208:223]
  v_add_u32 v6, 0xffff4000, v6
  s_waitcnt lgkmcnt(2)
  v_mfma_f32_32x32x16_bf16 v[160:175], v[32:35], v[24:27], v[160:175]
  ds_read_b128 v[44:47], v7
  ds_read_b64_tr_b16 v[52:53], v8 offset:6144
  v_mfma_f32_32x32x16_bf16 v[192:207], v[32:35], v[28:31], v[192:207]
  ds_read_b64_tr_b16 v[54:55], v8 offset:6656
  ds_read_b128 v[48:51], v7 offset:4096
  s_waitcnt lgkmcnt(4)
  v_mfma_f32_32x32x16_bf16 v[176:191], v[36:39], v[24:27], v[176:191]
  ds_read_b64_tr_b16 v[56:57], v9 offset:6144
  ds_read_b64_tr_b16 v[58:59], v9 offset:6656
  v_mfma_f32_32x32x16_bf16 v[208:223], v[36:39], v[28:31], v[208:223]
  v_add_u32 v7, 0xffff4000, v7
  v_add_u32 v8, 0x4000, v8
  v_add_u32 v9, 0x4000, v9
  s_waitcnt lgkmcnt(2)
  v_mfma_f32_32x32x16_bf16 v[160:175], v[52:55], v[44:47], v[160:175]
  s_waitcnt lgkmcnt(0)
  s_barrier
  ds_read_b128 v[24:27], v4
  v_mfma_f32_32x32x16_bf16 v[192:207], v[52:55], v[48:51], v[192:207]
  ds_read_b64_tr_b16 v[32:33], v8 offset:0
  ds_read_b64_tr_b16 v[34:35], v8 offset:512
  ds_read_b128 v[28:31], v4 offset:4096
  v_mfma_f32_32x32x16_bf16 v[176:191], v[56:59], v[44:47], v[176:191]
  ds_read_b64_tr_b16 v[36:37], v9 offset:0
  ds_read_b64_tr_b16 v[38:39], v9 offset:512
  v_mfma_f32_32x32x16_bf16 v[208:223], v[56:59], v[48:51], v[208:223]
  s_waitcnt lgkmcnt(2)
  v_mfma_f32_32x32x16_bf16 v[160:175], v[32:35], v[24:27], v[160:175]
  ds_read_b128 v[44:47], v5
  ds_read_b64_tr_b16 v[52:53], v8 offset:2048
  v_mfma_f32_32x32x16_bf16 v[192:207], v[32:35], v[28:31], v[192:207]
  ds_read_b64_tr_b16 v[54:55], v8 offset:2560
  ds_read_b128 v[48:51], v5 offset:4096
  s_waitcnt lgkmcnt(4)
  v_mfma_f32_32x32x16_bf16 v[176:191], v[36:39], v[24:27], v[176:191]
  ds_read_b64_tr_b16 v[56:57], v9 offset:2048
  ds_read_b64_tr_b16 v[58:59], v9 offset:2560
  v_mfma_f32_32x32x16_bf16 v[208:223], v[36:39], v[28:31], v[208:223]
  v_add_u32 v5, 0x4000, v5
  v_add_u32 v4, 0x4000, v4
  s_waitcnt lgkmcnt(2)
  v_mfma_f32_32x32x16_bf16 v[160:175], v[52:55], v[44:47], v[160:175]
  ds_read_b128 v[24:27], v6
  ds_read_b64_tr_b16 v[32:33], v8 offset:4096
  v_mfma_f32_32x32x16_bf16 v[192:207], v[52:55], v[48:51], v[192:207]
  ds_read_b64_tr_b16 v[34:35], v8 offset:4608
  ds_read_b128 v[28:31], v6 offset:4096
  s_waitcnt lgkmcnt(4)
  v_mfma_f32_32x32x16_bf16 v[176:191], v[56:59], v[44:47], v[176:191]
  ds_read_b64_tr_b16 v[36:37], v9 offset:4096
  ds_read_b64_tr_b16 v[38:39], v9 offset:4608
  v_mfma_f32_32x32x16_bf16 v[208:223], v[56:59], v[48:51], v[208:223]
  v_add_u32 v6, 0x4000, v6
  s_waitcnt lgkmcnt(2)
  v_mfma_f32_32x32x16_bf16 v[160:175], v[32:35], v[24:27], v[160:175]
  ds_read_b128 v[44:47], v7
  ds_read_b64_tr_b16 v[52:53], v8 offset:6144
  v_mfma_f32_32x32x16_bf16 v[192:207], v[32:35], v[28:31], v[192:207]
  ds_read_b64_tr_b16 v[54:55], v8 offset:6656
  ds_read_b128 v[48:51], v7 offset:4096
  s_waitcnt lgkmcnt(4)
  v_mfma_f32_32x32x16_bf16 v[176:191], v[36:39], v[24:27], v[176:191]
  ds_read_b64_tr_b16 v[56:57], v9 offset:6144
  ds_read_b64_tr_b16 v[58:59], v9 offset:6656
  v_mfma_f32_32x32x16_bf16 v[208:223], v[36:39], v[28:31], v[208:223]
  v_add_u32 v7, 0x4000, v7
  v_add_u32 v8, 0xffff4000, v8
  v_add_u32 v9, 0xffff4000, v9
  s_waitcnt lgkmcnt(2)
  v_mfma_f32_32x32x16_bf16 v[160:175], v[52:55], v[44:47], v[160:175]
  s_waitcnt lgkmcnt(0)
  s_barrier
  ds_read_b128 v[24:27], v4
  v_mfma_f32_32x32x16_bf16 v[192:207], v[52:55], v[48:51], v[192:207]
  ds_read_b64_tr_b16 v[32:33], v8 offset:0
  ds_read_b64_tr_b16 v[34:35], v8 offset:512
  ds_read_b128 v[28:31], v4 offset:4096
  v_mfma_f32_32x32x16_bf16 v[176:191], v[56:59], v[44:47], v[176:191]
  ds_read_b64_tr_b16 v[36:37], v9 offset:0
  ds_read_b64_tr_b16 v[38:39], v9 offset:512
  v_mfma_f32_32x32x16_bf16 v[208:223], v[56:59], v[48:51], v[208:223]
  s_waitcnt lgkmcnt(2)
  v_mfma_f32_32x32x16_bf16 v[160:175], v[32:35], v[24:27], v[160:175]
  ds_read_b128 v[44:47], v5
  ds_read_b64_tr_b16 v[52:53], v8 offset:2048
  v_mfma_f32_32x32x16_bf16 v[192:207], v[32:35], v[28:31], v[192:207]
  ds_read_b64_tr_b16 v[54:55], v8 offset:2560
  ds_read_b128 v[48:51], v5 offset:4096
  s_waitcnt lgkmcnt(4)
  v_mfma_f32_32x32x16_bf16 v[176:191], v[36:39], v[24:27], v[176:191]
  ds_read_b64_tr_b16 v[56:57], v9 offset:2048
  ds_read_b64_tr_b16 v[58:59], v9 offset:2560
  v_mfma_f32_32x32x16_bf16 v[208:223], v[36:39], v[28:31], v[208:223]
  v_add_u32 v5, 0x4000, v5
  v_add_u32 v4, 0x4000, v4
  s_waitcnt lgkmcnt(2)
  v_mfma_f32_32x32x16_bf16 v[160:175], v[52:55], v[44:47], v[160:175]
  ds_read_b128 v[24:27], v6
  ds_read_b64_tr_b16 v[32:33], v8 offset:4096
  v_mfma_f32_32x32x16_bf16 v[192:207], v[52:55], v[48:51], v[192:207]
  ds_read_b64_tr_b16 v[34:35], v8 offset:4608
  ds_read_b128 v[28:31], v6 offset:4096
  s_waitcnt lgkmcnt(4)
  v_mfma_f32_32x32x16_bf16 v[176:191], v[56:59], v[44:47], v[176:191]
  ds_read_b64_tr_b16 v[36:37], v9 offset:4096
  ds_read_b64_tr_b16 v[38:39], v9 offset:4608
  v_mfma_f32_32x32x16_bf16 v[208:223], v[56:59], v[48:51], v[208:223]
  v_add_u32 v6, 0x4000, v6
  s_waitcnt lgkmcnt(2)
  v_mfma_f32_32x32x16_bf16 v[160:175], v[32:35], v[24:27], v[160:175]
  ds_read_b128 v[44:47], v7
  ds_read_b64_tr_b16 v[52:53], v8 offset:6144
  v_mfma_f32_32x32x16_bf16 v[192:207], v[32:35], v[28:31], v[192:207]
  ds_read_b64_tr_b16 v[54:55], v8 offset:6656
  ds_read_b128 v[48:51], v7 offset:4096
  s_waitcnt lgkmcnt(4)
  v_mfma_f32_32x32x16_bf16 v[176:191], v[36:39], v[24:27], v[176:191]
  ds_read_b64_tr_b16 v[56:57], v9 offset:6144
  ds_read_b64_tr_b16 v[58:59], v9 offset:6656
  v_mfma_f32_32x32x16_bf16 v[208:223], v[36:39], v[28:31], v[208:223]
  v_add_u32 v7, 0x4000, v7
  v_add_u32 v8, 0x4000, v8
  v_add_u32 v9, 0x4000, v9
  s_waitcnt lgkmcnt(2)
  v_mfma_f32_32x32x16_bf16 v[160:175], v[52:55], v[44:47], v[160:175]
  s_waitcnt lgkmcnt(0)
  ds_read_b128 v[24:27], v4
  v_mfma_f32_32x32x16_bf16 v[192:207], v[52:55], v[48:51], v[192:207]
  ds_read_b64_tr_b16 v[32:33], v8 offset:0
  ds_read_b64_tr_b16 v[34:35], v8 offset:512
  ds_read_b128 v[28:31], v4 offset:4096
  v_mfma_f32_32x32x16_bf16 v[176:191], v[56:59], v[44:47], v[176:191]
  ds_read_b64_tr_b16 v[36:37], v9 offset:0
  ds_read_b64_tr_b16 v[38:39], v9 offset:512
  v_mfma_f32_32x32x16_bf16 v[208:223], v[56:59], v[48:51], v[208:223]
  s_waitcnt lgkmcnt(2)
  v_mfma_f32_32x32x16_bf16 v[160:175], v[32:35], v[24:27], v[160:175]
  ds_read_b128 v[44:47], v5
  ds_read_b64_tr_b16 v[52:53], v8 offset:2048
  v_mfma_f32_32x32x16_bf16 v[192:207], v[32:35], v[28:31], v[192:207]
  ds_read_b64_tr_b16 v[54:55], v8 offset:2560
  ds_read_b128 v[48:51], v5 offset:4096
  s_waitcnt lgkmcnt(4)
  v_mfma_f32_32x32x16_bf16 v[176:191], v[36:39], v[24:27], v[176:191]
  ds_read_b64_tr_b16 v[56:57], v9 offset:2048
  ds_read_b64_tr_b16 v[58:59], v9 offset:2560
  v_mfma_f32_32x32x16_bf16 v[208:223], v[36:39], v[28:31], v[208:223]
  v_add_u32 v5, 0x4000, v5
  v_add_u32 v4, 0x4000, v4
  s_waitcnt lgkmcnt(2)
  v_mfma_f32_32x32x16_bf16 v[160:175], v[52:55], v[44:47], v[160:175]
  ds_read_b128 v[24:27], v6
  ds_read_b64_tr_b16 v[32:33], v8 offset:4096
  v_mfma_f32_32x32x16_bf16 v[192:207], v[52:55], v[48:51], v[192:207]
  ds_read_b64_tr_b16 v[34:35], v8 offset:4608
  ds_read_b128 v[28:31], v6 offset:4096
  s_waitcnt lgkmcnt(4)
  v_mfma_f32_32x32x16_bf16 v[176:191], v[56:59], v[44:47], v[176:191]
  ds_read_b64_tr_b16 v[36:37], v9 offset:4096
  ds_read_b64_tr_b16 v[38:39], v9 offset:4608
  v_mfma_f32_32x32x16_bf16 v[208:223], v[56:59], v[48:51], v[208:223]
  v_add_u32 v6, 0x4000, v6
  s_waitcnt lgkmcnt(2)
  v_mfma_f32_32x32x16_bf16 v[160:175], v[32:35], v[24:27], v[160:175]
  ds_read_b128 v[44:47], v7
  ds_read_b64_tr_b16 v[52:53], v8 offset:6144
  v_mfma_f32_32x32x16_bf16 v[192:207], v[32:35], v[28:31], v[192:207]
  ds_read_b64_tr_b16 v[54:55], v8 offset:6656
  ds_read_b128 v[48:51], v7 offset:4096
  s_waitcnt lgkmcnt(4)
  v_mfma_f32_32x32x16_bf16 v[176:191], v[36:39], v[24:27], v[176:191]
  ds_read_b64_tr_b16 v[56:57], v9 offset:6144
  ds_read_b64_tr_b16 v[58:59], v9 offset:6656
  v_mfma_f32_32x32x16_bf16 v[208:223], v[36:39], v[28:31], v[208:223]
  v_add_u32 v7, 0x4000, v7
  v_add_u32 v8, 0x4000, v8
  v_add_u32 v9, 0x4000, v9
  ds_read_b32 v10, v0
  s_waitcnt lgkmcnt(2)
  v_mfma_f32_32x32x16_bf16 v[160:175], v[52:55], v[44:47], v[160:175]
  s_waitcnt lgkmcnt(0)
  v_readfirstlane_b32 s75, v10
  s_bitcmp1_b32 s75, 6
  s_cbranch_scc0 SQ_W
SQ_B:
  ds_read_b128 v[24:27], v4
  v_mfma_f32_32x32x16_bf16 v[192:207], v[52:55], v[48:51], v[192:207]
  ds_read_b64_tr_b16 v[32:33], v8 offset:0
  ds_read_b64_tr_b16 v[34:35], v8 offset:512
  ds_read_b128 v[28:31], v4 offset:4096
  v_mfma_f32_32x32x16_bf16 v[176:191], v[56:59], v[44:47], v[176:191]
  ds_read_b64_tr_b16 v[36:37], v9 offset:0
  ds_read_b64_tr_b16 v[38:39], v9 offset:512
  v_mfma_f32_32x32x16_bf16 v[208:223], v[56:59], v[48:51], v[208:223]
  s_waitcnt lgkmcnt(2)
  v_mfma_f32_32x32x16_bf16 v[160:175], v[32:35], v[24:27], v[160:175]
  ds_read_b128 v[44:47], v5
  ds_read_b64_tr_b16 v[52:53], v8 offset:2048
  v_mfma_f32_32x32x16_bf16 v[192:207], v[32:35], v[28:31], v[192:207]
  ds_read_b64_tr_b16 v[54:55], v8 offset:2560
  ds_read_b128 v[48:51], v5 offset:4096
  s_waitcnt lgkmcnt(4)
  v_mfma_f32_32x32x16_bf16 v[176:191], v[36:39], v[24:27], v[176:191]
  ds_read_b64_tr_b16 v[56:57], v9 offset:2048
  ds_read_b64_tr_b16 v[58:59], v9 offset:2560
  v_mfma_f32_32x32x16_bf16 v[208:223], v[36:39], v[28:31], v[208:223]
  s_waitcnt lgkmcnt(2)
  v_mfma_f32_32x32x16_bf16 v[160:175], v[52:55], v[44:47], v[160:175]
  ds_read_b128 v[24:27], v6
  ds_read_b64_tr_b16 v[32:33], v8 offset:4096
  v_mfma_f32_32x32x16_bf16 v[192:207], v[52:55], v[48:51], v[192:207]
  ds_read_b64_tr_b16 v[34:35], v8 offset:4608
  ds_read_b128 v[28:31], v6 offset:4096
  s_waitcnt lgkmcnt(4)
  v_mfma_f32_32x32x16_bf16 v[176:191], v[56:59], v[44:47], v[176:191]
  ds_read_b64_tr_b16 v[36:37], v9 offset:4096
  ds_read_b64_tr_b16 v[38:39], v9 offset:4608
  v_mfma_f32_32x32x16_bf16 v[208:223], v[56:59], v[48:51], v[208:223]
  s_waitcnt lgkmcnt(2)
  v_mfma_f32_32x32x16_bf16 v[160:175], v[32:35], v[24:27], v[160:175]
  ds_read_b128 v[44:47], v7
  ds_read_b64_tr_b16 v[52:53], v8 offset:6144
  v_mfma_f32_32x32x16_bf16 v[192:207], v[32:35], v[28:31], v[192:207]
  ds_read_b64_tr_b16 v[54:55], v8 offset:6656
  ds_read_b128 v[48:51], v7 offset:4096
  s_waitcnt lgkmcnt(4)
  v_mfma_f32_32x32x16_bf16 v[176:191], v[36:39], v[24:27], v[176:191]
  ds_read_b64_tr_b16 v[56:57], v9 offset:6144
  ds_read_b64_tr_b16 v[58:59], v9 offset:6656
  v_mfma_f32_32x32x16_bf16 v[208:223], v[36:39], v[28:31], v[208:223]
  s_waitcnt lgkmcnt(2)
  v_mfma_f32_32x32x16_bf16 v[160:175], v[52:55], v[44:47], v[160:175]
  s_waitcnt lgkmcnt(0)
  s_mov_b64 exec, 1
  ds_add_u32 v0, v1
  s_mov_b64 exec, -1
  v_mfma_f32_32x32x16_bf16 v[192:207], v[52:55], v[48:51], v[192:207]
  v_mfma_f32_32x32x16_bf16 v[176:191], v[56:59], v[44:47], v[176:191]
  v_mfma_f32_32x32x16_bf16 v[208:223], v[56:59], v[48:51], v[208:223]
  s_branch K1_GE2
SW2R:
  s_mov_b32 s34, 0xbdd2d3e8
  s_mov_b32 s35, s34
  s_waitcnt lgkmcnt(2)
  v_mfma_f32_32x32x16_bf16 v[160:175], v[32:35], v[24:27], v[160:175]
  ds_read_b128 v[44:47], v5
  ds_read_b64_tr_b16 v[52:53], v8 offset:2048
  v_mfma_f32_32x32x16_bf16 v[192:207], v[32:35], v[28:31], v[192:207]
  ds_read_b64_tr_b16 v[54:55], v8 offset:2560
  ds_read_b128 v[48:51], v5 offset:4096
  s_waitcnt lgkmcnt(4)
  v_mfma_f32_32x32x16_bf16 v[176:191], v[36:39], v[24:27], v[176:191]
  ds_read_b64_tr_b16 v[56:57], v9 offset:2048
  ds_read_b64_tr_b16 v[58:59], v9 offset:2560
  v_mfma_f32_32x32x16_bf16 v[208:223], v[36:39], v[28:31], v[208:223]
  v_add_u32 v5, 0x8000, v5
  v_add_u32 v4, 0x8000, v4
  s_waitcnt lgkmcnt(2)
  v_mfma_f32_32x32x16_bf16 v[160:175], v[52:55], v[44:47], v[160:175]
  ds_read_b128 v[24:27], v6
  ds_read_b64_tr_b16 v[32:33], v8 offset:4096
  v_cvt_pk_bf16_f32 v64, v224, v225
  v_cvt_pk_bf16_f32 v65, v226, v227
  v_cvt_pk_bf16_f32 v66, v228, v229
  v_mfma_f32_32x32x16_bf16 v[192:207], v[52:55], v[48:51], v[192:207]
  ds_read_b64_tr_b16 v[34:35], v8 offset:4608
  ds_read_b128 v[28:31], v6 offset:4096
  v_cvt_pk_bf16_f32 v67, v230, v231
  buffer_store_dwordx4 v[64:67], v11, s[28:31], s36 offen offset:0 sc1
  v_cvt_pk_bf16_f32 v68, v232, v233
  s_waitcnt lgkmcnt(4)
  v_mfma_f32_32x32x16_bf16 v[176:191], v[56:59], v[44:47], v[176:191]
  ds_read_b64_tr_b16 v[36:37], v9 offset:4096
  ds_read_b64_tr_b16 v[38:39], v9 offset:4608
  v_cvt_pk_bf16_f32 v69, v234, v235
  v_cvt_pk_bf16_f32 v70, v236, v237
  v_cvt_pk_bf16_f32 v71, v238, v239
  v_mfma_f32_32x32x16_bf16 v[208:223], v[56:59], v[48:51], v[208:223]
  v_add_u32 v6, 0x8000, v6
  buffer_store_dwordx4 v[68:71], v11, s[28:31], s37 offen offset:0 sc1
  v_cvt_pk_bf16_f32 v72, v240, v241
  v_cvt_pk_bf16_f32 v73, v242, v243
  v_cvt_pk_bf16_f32 v74, v244, v245
  s_waitcnt lgkmcnt(2)
  v_mfma_f32_32x32x16_bf16 v[160:175], v[32:35], v[24:27], v[160:175]
  ds_read_b128 v[44:47], v7
  ds_read_b64_tr_b16 v[52:53], v8 offset:6144
  v_cvt_pk_bf16_f32 v75, v246, v247
  buffer_store_dwordx4 v[72:75], v11, s[28:31], s36 offen offset:1024 sc1
  v_cvt_pk_bf16_f32 v76, v248, v249
  v_mfma_f32_32x32x16_bf16 v[192:207], v[32:35], v[28:31], v[192:207]
  ds_read_b64_tr_b16 v[54:55], v8 offset:6656
  ds_read_b128 v[48:51], v7 offset:4096
  v_cvt_pk_bf16_f32 v77, v250, v251
  v_cvt_pk_bf16_f32 v78, v252, v253
  v_cvt_pk_bf16_f32 v79, v254, v255
  s_waitcnt lgkmcnt(4)
  v_mfma_f32_32x32x16_bf16 v[176:191], v[36:39], v[24:27], v[176:191]
  ds_read_b64_tr_b16 v[56:57], v9 offset:6144
  ds_read_b64_tr_b16 v[58:59], v9 offset:6656
  buffer_store_dwordx4 v[76:79], v11, s[28:31], s37 offen offset:1024 sc1
  v_mul_f32 v16, v96, v96
  v_mul_f32 v17, v97, v97
  v_mfma_f32_32x32x16_bf16 v[208:223], v[36:39], v[28:31], v[208:223]
  v_add_u32 v7, 0x8000, v7
  v_add_u32 v8, 0xffff4000, v8
  v_add_u32 v9, 0xffff4000, v9
  v_mul_f32 v18, v98, v98
  v_mul_f32 v19, v99, v99
  s_waitcnt lgkmcnt(2)
  v_mfma_f32_32x32x16_bf16 v[160:175], v[52:55], v[44:47], v[160:175]
  v_mul_f32 v20, v100, v100
  v_mul_f32 v21, v101, v101
  v_mul_f32 v22, v102, v102
  v_mul_f32 v23, v103, v103
  s_waitcnt lgkmcnt(0)
  s_barrier
  ds_read_b128 v[24:27], v4
  v_mfma_f32_32x32x16_bf16 v[192:207], v[52:55], v[48:51], v[192:207]
  ds_read_b64_tr_b16 v[32:33], v8 offset:0
  ds_read_b64_tr_b16 v[34:35], v8 offset:512
  ds_read_b128 v[28:31], v4 offset:4096
  v_fma_f32 v16, v16, s34, v12
  v_fma_f32 v17, v17, s34, v12
  v_mfma_f32_32x32x16_bf16 v[176:191], v[56:59], v[44:47], v[176:191]
  ds_read_b64_tr_b16 v[36:37], v9 offset:0
  ds_read_b64_tr_b16 v[38:39], v9 offset:512
  v_fma_f32 v18, v18, s34, v12
  v_fma_f32 v19, v19, s34, v12
  v_fma_f32 v20, v20, s34, v12
  v_mfma_f32_32x32x16_bf16 v[208:223], v[56:59], v[48:51], v[208:223]
  v_fma_f32 v21, v21, s34, v12
  v_fma_f32 v22, v22, s34, v12
  v_fma_f32 v23, v23, s34, v12
  v_mul_f32 v16, v16, v96
  v_mul_f32 v17, v17, v97
  s_waitcnt lgkmcnt(2)
  v_mfma_f32_32x32x16_bf16 v[160:175], v[32:35], v[24:27], v[160:175]
  ds_read_b128 v[44:47], v5
  ds_read_b64_tr_b16 v[52:53], v8 offset:2048
  v_mul_f32 v18, v18, v98
  v_mul_f32 v19, v19, v99
  v_mul_f32 v20, v20, v100
  v_mfma_f32_32x32x16_bf16 v[192:207], v[32:35], v[28:31], v[192:207]
  ds_read_b64_tr_b16 v[54:55], v8 offset:2560
  ds_read_b128 v[48:51], v5 offset:4096
  v_mul_f32 v21, v21, v101
  v_mul_f32 v22, v22, v102
  v_mul_f32 v23, v23, v103
  s_waitcnt lgkmcnt(4)
  v_mfma_f32_32x32x16_bf16 v[176:191], v[36:39], v[24:27], v[176:191]
  ds_read_b64_tr_b16 v[56:57], v9 offset:2048
  ds_read_b64_tr_b16 v[58:59], v9 offset:2560
  v_exp_f32 v16, v16
  v_mul_f32 v104, v104, v96
  v_mfma_f32_32x32x16_bf16 v[208:223], v[36:39], v[28:31], v[208:223]
  v_add_u32 v5, 0x4000, v5
  v_add_u32 v4, 0x4000, v4
  v_exp_f32 v17, v17
  v_mul_f32 v105, v105, v97
  s_waitcnt lgkmcnt(2)
  v_mfma_f32_32x32x16_bf16 v[160:175], v[52:55], v[44:47], v[160:175]
  ds_read_b128 v[24:27], v6
  ds_read_b64_tr_b16 v[32:33], v8 offset:4096
  v_exp_f32 v18, v18
  v_mul_f32 v106, v106, v98
  v_mfma_f32_32x32x16_bf16 v[192:207], v[52:55], v[48:51], v[192:207]
  ds_read_b64_tr_b16 v[34:35], v8 offset:4608
  ds_read_b128 v[28:31], v6 offset:4096
  v_exp_f32 v19, v19
  v_mul_f32 v107, v107, v99
  s_waitcnt lgkmcnt(4)
  v_mfma_f32_32x32x16_bf16 v[176:191], v[56:59], v[44:47], v[176:191]
  ds_read_b64_tr_b16 v[36:37], v9 offset:4096
  ds_read_b64_tr_b16 v[38:39], v9 offset:4608
  v_exp_f32 v20, v20
  v_mul_f32 v108, v108, v100
  v_mfma_f32_32x32x16_bf16 v[208:223], v[56:59], v[48:51], v[208:223]
  v_add_u32 v6, 0x4000, v6
  v_exp_f32 v21, v21
  v_mul_f32 v109, v109, v101
  s_waitcnt lgkmcnt(2)
  v_mfma_f32_32x32x16_bf16 v[160:175], v[32:35], v[24:27], v[160:175]
  ds_read_b128 v[44:47], v7
  ds_read_b64_tr_b16 v[52:53], v8 offset:6144
  v_exp_f32 v22, v22
  v_mul_f32 v110, v110, v102
  v_mfma_f32_32x32x16_bf16 v[192:207], v[32:35], v[28:31], v[192:207]
  ds_read_b64_tr_b16 v[54:55], v8 offset:6656
  ds_read_b128 v[48:51], v7 offset:4096
  v_exp_f32 v23, v23
  v_mul_f32 v111, v111, v103
  s_waitcnt lgkmcnt(4)
  v_mfma_f32_32x32x16_bf16 v[176:191], v[36:39], v[24:27], v[176:191]
  ds_read_b64_tr_b16 v[56:57], v9 offset:6144
  ds_read_b64_tr_b16 v[58:59], v9 offset:6656
  v_add_f32 v16, 1.0, v16
  v_add_f32 v17, 1.0, v17
  v_add_f32 v18, 1.0, v18
  v_mfma_f32_32x32x16_bf16 v[208:223], v[36:39], v[28:31], v[208:223]
  v_add_u32 v7, 0x4000, v7
  v_add_u32 v8, 0x4000, v8
  v_add_u32 v9, 0x4000, v9
  v_add_f32 v19, 1.0, v19
  v_add_f32 v20, 1.0, v20
  s_waitcnt lgkmcnt(2)
  v_mfma_f32_32x32x16_bf16 v[160:175], v[52:55], v[44:47], v[160:175]
  v_add_f32 v21, 1.0, v21
  v_add_f32 v22, 1.0, v22
  v_add_f32 v23, 1.0, v23
  s_waitcnt vmcnt(0)
  s_waitcnt lgkmcnt(0)
  s_barrier
  ds_read_b128 v[24:27], v4
  v_mfma_f32_32x32x16_bf16 v[192:207], v[52:55], v[48:51], v[192:207]
  ds_read_b64_tr_b16 v[32:33], v8 offset:0
  ds_read_b64_tr_b16 v[34:35], v8 offset:512
  ds_read_b128 v[28:31], v4 offset:4096
  v_rcp_f32 v16, v16
  v_mfma_f32_32x32x16_bf16 v[176:191], v[56:59], v[44:47], v[176:191]
  ds_read_b64_tr_b16 v[36:37], v9 offset:0
  ds_read_b64_tr_b16 v[38:39], v9 offset:512
  v_rcp_f32 v17, v17
  v_mfma_f32_32x32x16_bf16 v[208:223], v[56:59], v[48:51], v[208:223]
  v_rcp_f32 v18, v18
  v_mul_f32 v104, v104, v16
  v_rcp_f32 v19, v19
  s_waitcnt lgkmcnt(2)
  v_mfma_f32_32x32x16_bf16 v[160:175], v[32:35], v[24:27], v[160:175]
  ds_read_b128 v[44:47], v5
  ds_read_b64_tr_b16 v[52:53], v8 offset:2048
  v_mul_f32 v105, v105, v17
  v_rcp_f32 v20, v20
  v_mfma_f32_32x32x16_bf16 v[192:207], v[32:35], v[28:31], v[192:207]
  ds_read_b64_tr_b16 v[54:55], v8 offset:2560
  ds_read_b128 v[48:51], v5 offset:4096
  v_mul_f32 v106, v106, v18
  v_rcp_f32 v21, v21
  s_waitcnt lgkmcnt(4)
  v_mfma_f32_32x32x16_bf16 v[176:191], v[36:39], v[24:27], v[176:191]
  ds_read_b64_tr_b16 v[56:57], v9 offset:2048
  ds_read_b64_tr_b16 v[58:59], v9 offset:2560
  v_mul_f32 v107, v107, v19
  v_rcp_f32 v22, v22
  v_mfma_f32_32x32x16_bf16 v[208:223], v[36:39], v[28:31], v[208:223]
  v_add_u32 v5, 0x4000, v5
  v_add_u32 v4, 0x4000, v4
  v_mul_f32 v108, v108, v20
  v_rcp_f32 v23, v23
  s_waitcnt lgkmcnt(2)
  v_mfma_f32_32x32x16_bf16 v[160:175], v[52:55], v[44:47], v[160:175]
  ds_read_b128 v[24:27], v6
  ds_read_b64_tr_b16 v[32:33], v8 offset:4096
  v_mul_f32 v109, v109, v21
  v_mul_f32 v110, v110, v22
  v_mul_f32 v111, v111, v23
  v_mfma_f32_32x32x16_bf16 v[192:207], v[52:55], v[48:51], v[192:207]
  ds_read_b64_tr_b16 v[34:35], v8 offset:4608
  ds_read_b128 v[28:31], v6 offset:4096
  v_cvt_pk_bf16_f32 v80, v104, v105
  v_cvt_pk_bf16_f32 v81, v106, v107
  v_cvt_pk_bf16_f32 v82, v108, v109
  s_waitcnt lgkmcnt(4)
  v_mfma_f32_32x32x16_bf16 v[176:191], v[56:59], v[44:47], v[176:191]
  ds_read_b64_tr_b16 v[36:37], v9 offset:4096
  ds_read_b64_tr_b16 v[38:39], v9 offset:4608
  v_cvt_pk_bf16_f32 v83, v110, v111
  v_mul_f32 v16, v112, v112
  v_mul_f32 v17, v113, v113
  v_mfma_f32_32x32x16_bf16 v[208:223], v[56:59], v[48:51], v[208:223]
  v_add_u32 v6, 0x4000, v6
  v_mul_f32 v18, v114, v114
  v_mul_f32 v19, v115, v115
  v_mul_f32 v20, v116, v116
  v_mul_f32 v21, v117, v117
  s_waitcnt lgkmcnt(2)
  v_mfma_f32_32x32x16_bf16 v[160:175], v[32:35], v[24:27], v[160:175]
  ds_read_b128 v[44:47], v7
  ds_read_b64_tr_b16 v[52:53], v8 offset:6144
  v_mul_f32 v22, v118, v118
  v_mul_f32 v23, v119, v119
  v_fma_f32 v16, v16, s34, v12
  v_mfma_f32_32x32x16_bf16 v[192:207], v[32:35], v[28:31], v[192:207]
  ds_read_b64_tr_b16 v[54:55], v8 offset:6656
  ds_read_b128 v[48:51], v7 offset:4096
  v_fma_f32 v17, v17, s34, v12
  v_fma_f32 v18, v18, s34, v12
  v_fma_f32 v19, v19, s34, v12
  s_waitcnt lgkmcnt(4)
  v_mfma_f32_32x32x16_bf16 v[176:191], v[36:39], v[24:27], v[176:191]
  ds_read_b64_tr_b16 v[56:57], v9 offset:6144
  ds_read_b64_tr_b16 v[58:59], v9 offset:6656
  v_fma_f32 v20, v20, s34, v12
  v_fma_f32 v21, v21, s34, v12
  v_fma_f32 v22, v22, s34, v12
  v_mfma_f32_32x32x16_bf16 v[208:223], v[36:39], v[28:31], v[208:223]
  v_add_u32 v7, 0x4000, v7
  v_add_u32 v8, 0x4000, v8
  v_add_u32 v9, 0x4000, v9
  v_fma_f32 v23, v23, s34, v12
  v_mul_f32 v16, v16, v112
  s_waitcnt lgkmcnt(2)
  v_mfma_f32_32x32x16_bf16 v[160:175], v[52:55], v[44:47], v[160:175]
  v_mul_f32 v17, v17, v113
  v_mul_f32 v18, v18, v114
  v_mul_f32 v19, v19, v115
  v_mul_f32 v20, v20, v116
  s_waitcnt lgkmcnt(0)
  s_barrier
  ds_read_b128 v[24:27], v4
  v_mfma_f32_32x32x16_bf16 v[192:207], v[52:55], v[48:51], v[192:207]
  ds_read_b64_tr_b16 v[32:33], v8 offset:0
  ds_read_b64_tr_b16 v[34:35], v8 offset:512
  ds_read_b128 v[28:31], v4 offset:4096
  v_mul_f32 v21, v21, v117
  v_mul_f32 v22, v22, v118
  v_mfma_f32_32x32x16_bf16 v[176:191], v[56:59], v[44:47], v[176:191]
  ds_read_b64_tr_b16 v[36:37], v9 offset:0
  ds_read_b64_tr_b16 v[38:39], v9 offset:512
  v_mul_f32 v23, v23, v119
  v_exp_f32 v16, v16
  v_mfma_f32_32x32x16_bf16 v[208:223], v[56:59], v[48:51], v[208:223]
  v_mul_f32 v120, v120, v112
  v_exp_f32 v17, v17
  v_mul_f32 v121, v121, v113
  s_waitcnt lgkmcnt(2)
  v_mfma_f32_32x32x16_bf16 v[160:175], v[32:35], v[24:27], v[160:175]
  ds_read_b128 v[44:47], v5
  ds_read_b64_tr_b16 v[52:53], v8 offset:2048
  v_exp_f32 v18, v18
  v_mul_f32 v122, v122, v114
  v_mfma_f32_32x32x16_bf16 v[192:207], v[32:35], v[28:31], v[192:207]
  ds_read_b64_tr_b16 v[54:55], v8 offset:2560
  ds_read_b128 v[48:51], v5 offset:4096
  v_exp_f32 v19, v19
  v_mul_f32 v123, v123, v115
  s_waitcnt lgkmcnt(4)
  v_mfma_f32_32x32x16_bf16 v[176:191], v[36:39], v[24:27], v[176:191]
  ds_read_b64_tr_b16 v[56:57], v9 offset:2048
  ds_read_b64_tr_b16 v[58:59], v9 offset:2560
  v_exp_f32 v20, v20
  v_mul_f32 v124, v124, v116
  v_mfma_f32_32x32x16_bf16 v[208:223], v[36:39], v[28:31], v[208:223]
  v_add_u32 v5, 0xffff4000, v5
  v_add_u32 v4, 0xffff4000, v4
  v_exp_f32 v21, v21
  v_mul_f32 v125, v125, v117
  s_waitcnt lgkmcnt(2)
  v_mfma_f32_32x32x16_bf16 v[160:175], v[52:55], v[44:47], v[160:175]
  ds_read_b128 v[24:27], v6
  ds_read_b64_tr_b16 v[32:33], v8 offset:4096
  v_exp_f32 v22, v22
  v_mul_f32 v126, v126, v118
  v_mfma_f32_32x32x16_bf16 v[192:207], v[52:55], v[48:51], v[192:207]
  ds_read_b64_tr_b16 v[34:35], v8 offset:4608
  ds_read_b128 v[28:31], v6 offset:4096
  v_exp_f32 v23, v23
  v_mul_f32 v127, v127, v119
  s_waitcnt lgkmcnt(4)
  v_mfma_f32_32x32x16_bf16 v[176:191], v[56:59], v[44:47], v[176:191]
  ds_read_b64_tr_b16 v[36:37], v9 offset:4096
  ds_read_b64_tr_b16 v[38:39], v9 offset:4608
  v_add_f32 v16, 1.0, v16
  v_add_f32 v17, 1.0, v17
  v_add_f32 v18, 1.0, v18
  v_mfma_f32_32x32x16_bf16 v[208:223], v[56:59], v[48:51], v[208:223]
  v_add_u32 v6, 0xffff4000, v6
  v_add_f32 v19, 1.0, v19
  v_add_f32 v20, 1.0, v20
  v_add_f32 v21, 1.0, v21
  v_add_f32 v22, 1.0, v22
  s_waitcnt lgkmcnt(2)
  v_mfma_f32_32x32x16_bf16 v[160:175], v[32:35], v[24:27], v[160:175]
  ds_read_b128 v[44:47], v7
  ds_read_b64_tr_b16 v[52:53], v8 offset:6144
  v_add_f32 v23, 1.0, v23
  v_rcp_f32 v16, v16
  v_mfma_f32_32x32x16_bf16 v[192:207], v[32:35], v[28:31], v[192:207]
  ds_read_b64_tr_b16 v[54:55], v8 offset:6656
  ds_read_b128 v[48:51], v7 offset:4096
  v_rcp_f32 v17, v17
  s_waitcnt lgkmcnt(4)
  v_mfma_f32_32x32x16_bf16 v[176:191], v[36:39], v[24:27], v[176:191]
  ds_read_b64_tr_b16 v[56:57], v9 offset:6144
  ds_read_b64_tr_b16 v[58:59], v9 offset:6656
  v_rcp_f32 v18, v18
  v_mul_f32 v120, v120, v16
  v_mfma_f32_32x32x16_bf16 v[208:223], v[36:39], v[28:31], v[208:223]
  v_add_u32 v7, 0xffff4000, v7
  v_add_u32 v8, 0x4000, v8
  v_add_u32 v9, 0x4000, v9
  v_rcp_f32 v19, v19
  s_waitcnt lgkmcnt(2)
  v_mfma_f32_32x32x16_bf16 v[160:175], v[52:55], v[44:47], v[160:175]
  v_mul_f32 v121, v121, v17
  v_rcp_f32 v20, v20
  v_mul_f32 v122, v122, v18
  s_waitcnt lgkmcnt(0)
  s_barrier
  ds_read_b128 v[24:27], v4
  v_mfma_f32_32x32x16_bf16 v[192:207], v[52:55], v[48:51], v[192:207]
  ds_read_b64_tr_b16 v[32:33], v8 offset:0
  ds_read_b64_tr_b16 v[34:35], v8 offset:512
  ds_read_b128 v[28:31], v4 offset:4096
  v_rcp_f32 v21, v21
  v_mfma_f32_32x32x16_bf16 v[176:191], v[56:59], v[44:47], v[176:191]
  ds_read_b64_tr_b16 v[36:37], v9 offset:0
  ds_read_b64_tr_b16 v[38:39], v9 offset:512
  v_mul_f32 v123, v123, v19
  v_rcp_f32 v22, v22
  v_mfma_f32_32x32x16_bf16 v[208:223], v[56:59], v[48:51], v[208:223]
  v_mul_f32 v124, v124, v20
  v_rcp_f32 v23, v23
  v_mul_f32 v125, v125, v21
  v_mul_f32 v126, v126, v22
  s_waitcnt lgkmcnt(2)
  v_mfma_f32_32x32x16_bf16 v[160:175], v[32:35], v[24:27], v[160:175]
  ds_read_b128 v[44:47], v5
  ds_read_b64_tr_b16 v[52:53], v8 offset:2048
  v_mul_f32 v127, v127, v23
  v_cvt_pk_bf16_f32 v84, v120, v121
  v_cvt_pk_bf16_f32 v85, v122, v123
  v_mfma_f32_32x32x16_bf16 v[192:207], v[32:35], v[28:31], v[192:207]
  ds_read_b64_tr_b16 v[54:55], v8 offset:2560
  ds_read_b128 v[48:51], v5 offset:4096
  v_cvt_pk_bf16_f32 v86, v124, v125
  v_cvt_pk_bf16_f32 v87, v126, v127
  v_mul_f32 v16, v128, v128
  s_waitcnt lgkmcnt(4)
  v_mfma_f32_32x32x16_bf16 v[176:191], v[36:39], v[24:27], v[176:191]
  ds_read_b64_tr_b16 v[56:57], v9 offset:2048
  ds_read_b64_tr_b16 v[58:59], v9 offset:2560
  v_mul_f32 v17, v129, v129
  v_mul_f32 v18, v130, v130
  v_mul_f32 v19, v131, v131
  v_mfma_f32_32x32x16_bf16 v[208:223], v[36:39], v[28:31], v[208:223]
  v_add_u32 v5, 0x4000, v5
  v_add_u32 v4, 0x4000, v4
  v_mul_f32 v20, v132, v132
  v_mul_f32 v21, v133, v133
  v_mul_f32 v22, v134, v134
  s_waitcnt lgkmcnt(2)
  v_mfma_f32_32x32x16_bf16 v[160:175], v[52:55], v[44:47], v[160:175]
  ds_read_b128 v[24:27], v6
  ds_read_b64_tr_b16 v[32:33], v8 offset:4096
  v_mul_f32 v23, v135, v135
  v_fma_f32 v16, v16, s34, v12
  v_fma_f32 v17, v17, s34, v12
  v_mfma_f32_32x32x16_bf16 v[192:207], v[52:55], v[48:51], v[192:207]
  ds_read_b64_tr_b16 v[34:35], v8 offset:4608
  ds_read_b128 v[28:31], v6 offset:4096
  v_fma_f32 v18, v18, s34, v12
  v_fma_f32 v19, v19, s34, v12
  v_fma_f32 v20, v20, s34, v12
  s_waitcnt lgkmcnt(4)
  v_mfma_f32_32x32x16_bf16 v[176:191], v[56:59], v[44:47], v[176:191]
  ds_read_b64_tr_b16 v[36:37], v9 offset:4096
  ds_read_b64_tr_b16 v[38:39], v9 offset:4608
  v_fma_f32 v21, v21, s34, v12
  v_fma_f32 v22, v22, s34, v12
  v_fma_f32 v23, v23, s34, v12
  v_mfma_f32_32x32x16_bf16 v[208:223], v[56:59], v[48:51], v[208:223]
  v_add_u32 v6, 0x4000, v6
  v_mul_f32 v16, v16, v128
  v_mul_f32 v17, v17, v129
  v_mul_f32 v18, v18, v130
  v_mul_f32 v19, v19, v131
  s_waitcnt lgkmcnt(2)
  v_mfma_f32_32x32x16_bf16 v[160:175], v[32:35], v[24:27], v[160:175]
  ds_read_b128 v[44:47], v7
  ds_read_b64_tr_b16 v[52:53], v8 offset:6144
  v_mul_f32 v20, v20, v132
  v_mul_f32 v21, v21, v133
  v_mul_f32 v22, v22, v134
  v_mfma_f32_32x32x16_bf16 v[192:207], v[32:35], v[28:31], v[192:207]
  ds_read_b64_tr_b16 v[54:55], v8 offset:6656
  ds_read_b128 v[48:51], v7 offset:4096
  v_mul_f32 v23, v23, v135
  v_exp_f32 v16, v16
  s_waitcnt lgkmcnt(4)
  v_mfma_f32_32x32x16_bf16 v[176:191], v[36:39], v[24:27], v[176:191]
  ds_read_b64_tr_b16 v[56:57], v9 offset:6144
  ds_read_b64_tr_b16 v[58:59], v9 offset:6656
  v_mul_f32 v136, v136, v128
  v_exp_f32 v17, v17
  v_mfma_f32_32x32x16_bf16 v[208:223], v[36:39], v[28:31], v[208:223]
  v_add_u32 v7, 0x4000, v7
  v_add_u32 v8, 0xffff4000, v8
  v_add_u32 v9, 0xffff4000, v9
  v_mul_f32 v137, v137, v129
  s_waitcnt lgkmcnt(2)
  v_mfma_f32_32x32x16_bf16 v[160:175], v[52:55], v[44:47], v[160:175]
  v_exp_f32 v18, v18
  v_mul_f32 v138, v138, v130
  s_waitcnt lgkmcnt(0)
  s_barrier
  ds_read_b128 v[24:27], v4
  v_mfma_f32_32x32x16_bf16 v[192:207], v[52:55], v[48:51], v[192:207]
  ds_read_b64_tr_b16 v[32:33], v8 offset:0
  ds_read_b64_tr_b16 v[34:35], v8 offset:512
  ds_read_b128 v[28:31], v4 offset:4096
  v_exp_f32 v19, v19
  v_mfma_f32_32x32x16_bf16 v[176:191], v[56:59], v[44:47], v[176:191]
  ds_read_b64_tr_b16 v[36:37], v9 offset:0
  ds_read_b64_tr_b16 v[38:39], v9 offset:512
  v_mul_f32 v139, v139, v131
  v_exp_f32 v20, v20
  v_mfma_f32_32x32x16_bf16 v[208:223], v[56:59], v[48:51], v[208:223]
  v_mul_f32 v140, v140, v132
  v_exp_f32 v21, v21
  v_mul_f32 v141, v141, v133
  s_waitcnt lgkmcnt(2)
  v_mfma_f32_32x32x16_bf16 v[160:175], v[32:35], v[24:27], v[160:175]
  ds_read_b128 v[44:47], v5
  ds_read_b64_tr_b16 v[52:53], v8 offset:2048
  v_exp_f32 v22, v22
  v_mul_f32 v142, v142, v134
  v_mfma_f32_32x32x16_bf16 v[192:207], v[32:35], v[28:31], v[192:207]
  ds_read_b64_tr_b16 v[54:55], v8 offset:2560
  ds_read_b128 v[48:51], v5 offset:4096
  v_exp_f32 v23, v23
  v_mul_f32 v143, v143, v135
  s_waitcnt lgkmcnt(4)
  v_mfma_f32_32x32x16_bf16 v[176:191], v[36:39], v[24:27], v[176:191]
  ds_read_b64_tr_b16 v[56:57], v9 offset:2048
  ds_read_b64_tr_b16 v[58:59], v9 offset:2560
  v_add_f32 v16, 1.0, v16
  v_add_f32 v17, 1.0, v17
  v_add_f32 v18, 1.0, v18
  v_mfma_f32_32x32x16_bf16 v[208:223], v[36:39], v[28:31], v[208:223]
  v_add_u32 v5, 0x4000, v5
  v_add_u32 v4, 0x4000, v4
  v_add_f32 v19, 1.0, v19
  v_add_f32 v20, 1.0, v20
  v_add_f32 v21, 1.0, v21
  s_waitcnt lgkmcnt(2)
  v_mfma_f32_32x32x16_bf16 v[160:175], v[52:55], v[44:47], v[160:175]
  ds_read_b128 v[24:27], v6
  ds_read_b64_tr_b16 v[32:33], v8 offset:4096
  v_add_f32 v22, 1.0, v22
  v_add_f32 v23, 1.0, v23
  v_mfma_f32_32x32x16_bf16 v[192:207], v[52:55], v[48:51], v[192:207]
  ds_read_b64_tr_b16 v[34:35], v8 offset:4608
  ds_read_b128 v[28:31], v6 offset:4096
  v_rcp_f32 v16, v16
  s_waitcnt lgkmcnt(4)
  v_mfma_f32_32x32x16_bf16 v[176:191], v[56:59], v[44:47], v[176:191]
  ds_read_b64_tr_b16 v[36:37], v9 offset:4096
  ds_read_b64_tr_b16 v[38:39], v9 offset:4608
  v_rcp_f32 v17, v17
  v_mfma_f32_32x32x16_bf16 v[208:223], v[56:59], v[48:51], v[208:223]
  v_add_u32 v6, 0x4000, v6
  v_rcp_f32 v18, v18
  v_mul_f32 v136, v136, v16
  s_waitcnt lgkmcnt(2)
  v_mfma_f32_32x32x16_bf16 v[160:175], v[32:35], v[24:27], v[160:175]
  ds_read_b128 v[44:47], v7
  ds_read_b64_tr_b16 v[52:53], v8 offset:6144
  v_rcp_f32 v19, v19
  v_mul_f32 v137, v137, v17
  v_mfma_f32_32x32x16_bf16 v[192:207], v[32:35], v[28:31], v[192:207]
  ds_read_b64_tr_b16 v[54:55], v8 offset:6656
  ds_read_b128 v[48:51], v7 offset:4096
  v_rcp_f32 v20, v20
  v_mul_f32 v138, v138, v18
  s_waitcnt lgkmcnt(4)
  v_mfma_f32_32x32x16_bf16 v[176:191], v[36:39], v[24:27], v[176:191]
  ds_read_b64_tr_b16 v[56:57], v9 offset:6144
  ds_read_b64_tr_b16 v[58:59], v9 offset:6656
  v_rcp_f32 v21, v21
  v_mul_f32 v139, v139, v19
  v_mfma_f32_32x32x16_bf16 v[208:223], v[36:39], v[28:31], v[208:223]
  v_add_u32 v7, 0x4000, v7
  v_add_u32 v8, 0x4000, v8
  v_add_u32 v9, 0x4000, v9
  v_rcp_f32 v22, v22
  s_waitcnt lgkmcnt(2)
  v_mfma_f32_32x32x16_bf16 v[160:175], v[52:55], v[44:47], v[160:175]
  v_mul_f32 v140, v140, v20
  v_rcp_f32 v23, v23
  v_mul_f32 v141, v141, v21
  s_waitcnt lgkmcnt(0)
  ds_read_b128 v[24:27], v4
  v_mfma_f32_32x32x16_bf16 v[192:207], v[52:55], v[48:51], v[192:207]
  ds_read_b64_tr_b16 v[32:33], v8 offset:0
  ds_read_b64_tr_b16 v[34:35], v8 offset:512
  ds_read_b128 v[28:31], v4 offset:4096
  v_mul_f32 v142, v142, v22
  v_mul_f32 v143, v143, v23
  v_mfma_f32_32x32x16_bf16 v[176:191], v[56:59], v[44:47], v[176:191]
  ds_read_b64_tr_b16 v[36:37], v9 offset:0
  ds_read_b64_tr_b16 v[38:39], v9 offset:512
  v_cvt_pk_bf16_f32 v88, v136, v137
  v_cvt_pk_bf16_f32 v89, v138, v139
  v_cvt_pk_bf16_f32 v90, v140, v141
  v_mfma_f32_32x32x16_bf16 v[208:223], v[56:59], v[48:51], v[208:223]
  v_cvt_pk_bf16_f32 v91, v142, v143
  v_mul_f32 v16, v144, v144
  v_mul_f32 v17, v145, v145
  v_mul_f32 v18, v146, v146
  v_mul_f32 v19, v147, v147
  s_waitcnt lgkmcnt(2)
  v_mfma_f32_32x32x16_bf16 v[160:175], v[32:35], v[24:27], v[160:175]
  ds_read_b128 v[44:47], v5
  ds_read_b64_tr_b16 v[52:53], v8 offset:2048
  v_mul_f32 v20, v148, v148
  v_mul_f32 v21, v149, v149
  v_mul_f32 v22, v150, v150
  v_mfma_f32_32x32x16_bf16 v[192:207], v[32:35], v[28:31], v[192:207]
  ds_read_b64_tr_b16 v[54:55], v8 offset:2560
  ds_read_b128 v[48:51], v5 offset:4096
  v_mul_f32 v23, v151, v151
  v_fma_f32 v16, v16, s34, v12
  v_fma_f32 v17, v17, s34, v12
  s_waitcnt lgkmcnt(4)
  v_mfma_f32_32x32x16_bf16 v[176:191], v[36:39], v[24:27], v[176:191]
  ds_read_b64_tr_b16 v[56:57], v9 offset:2048
  ds_read_b64_tr_b16 v[58:59], v9 offset:2560
  v_fma_f32 v18, v18, s34, v12
  v_fma_f32 v19, v19, s34, v12
  v_fma_f32 v20, v20, s34, v12
  v_mfma_f32_32x32x16_bf16 v[208:223], v[36:39], v[28:31], v[208:223]
  v_add_u32 v5, 0x4000, v5
  v_add_u32 v4, 0x4000, v4
  v_fma_f32 v21, v21, s34, v12
  v_fma_f32 v22, v22, s34, v12
  v_fma_f32 v23, v23, s34, v12
  s_waitcnt lgkmcnt(2)
  v_mfma_f32_32x32x16_bf16 v[160:175], v[52:55], v[44:47], v[160:175]
  ds_read_b128 v[24:27], v6
  ds_read_b64_tr_b16 v[32:33], v8 offset:4096
  v_mul_f32 v16, v16, v144
  v_mul_f32 v17, v17, v145
  v_mul_f32 v18, v18, v146
  v_mfma_f32_32x32x16_bf16 v[192:207], v[52:55], v[48:51], v[192:207]
  ds_read_b64_tr_b16 v[34:35], v8 offset:4608
  ds_read_b128 v[28:31], v6 offset:4096
  v_mul_f32 v19, v19, v147
  v_mul_f32 v20, v20, v148
  v_mul_f32 v21, v21, v149
  s_waitcnt lgkmcnt(4)
  v_mfma_f32_32x32x16_bf16 v[176:191], v[56:59], v[44:47], v[176:191]
  ds_read_b64_tr_b16 v[36:37], v9 offset:4096
  ds_read_b64_tr_b16 v[38:39], v9 offset:4608
  v_mul_f32 v22, v22, v150
  v_mul_f32 v23, v23, v151
  v_mfma_f32_32x32x16_bf16 v[208:223], v[56:59], v[48:51], v[208:223]
  v_add_u32 v6, 0x4000, v6
  v_exp_f32 v16, v16
  v_mul_f32 v152, v152, v144
  s_waitcnt lgkmcnt(2)
  v_mfma_f32_32x32x16_bf16 v[160:175], v[32:35], v[24:27], v[160:175]
  ds_read_b128 v[44:47], v7
  ds_read_b64_tr_b16 v[52:53], v8 offset:6144
  v_exp_f32 v17, v17
  v_mul_f32 v153, v153, v145
  v_mfma_f32_32x32x16_bf16 v[192:207], v[32:35], v[28:31], v[192:207]
  ds_read_b64_tr_b16 v[54:55], v8 offset:6656
  ds_read_b128 v[48:51], v7 offset:4096
  v_exp_f32 v18, v18
  v_mul_f32 v154, v154, v146
  s_waitcnt lgkmcnt(4)
  v_mfma_f32_32x32x16_bf16 v[176:191], v[36:39], v[24:27], v[176:191]
  ds_read_b64_tr_b16 v[56:57], v9 offset:6144
  ds_read_b64_tr_b16 v[58:59], v9 offset:6656
  v_exp_f32 v19, v19
  v_mul_f32 v155, v155, v147
  v_mfma_f32_32x32x16_bf16 v[208:223], v[36:39], v[28:31], v[208:223]
  v_add_u32 v7, 0x4000, v7
  v_add_u32 v8, 0x4000, v8
  v_add_u32 v9, 0x4000, v9
  ds_read_b32 v10, v0
  s_waitcnt lgkmcnt(2)
  v_mfma_f32_32x32x16_bf16 v[160:175], v[52:55], v[44:47], v[160:175]
  v_exp_f32 v20, v20
  v_mul_f32 v156, v156, v148
  s_waitcnt lgkmcnt(0)
  v_readfirstlane_b32 s75, v10
  s_bitcmp1_b32 s75, 6
  s_cbranch_scc0 SR_W
SR_B:
  ds_read_b128 v[24:27], v4
  v_mfma_f32_32x32x16_bf16 v[192:207], v[52:55], v[48:51], v[192:207]
  ds_read_b64_tr_b16 v[32:33], v8 offset:0
  ds_read_b64_tr_b16 v[34:35], v8 offset:512
  ds_read_b128 v[28:31], v4 offset:4096
  v_exp_f32 v21, v21
  v_mfma_f32_32x32x16_bf16 v[176:191], v[56:59], v[44:47], v[176:191]
  ds_read_b64_tr_b16 v[36:37], v9 offset:0
  ds_read_b64_tr_b16 v[38:39], v9 offset:512
  v_mul_f32 v157, v157, v149
  v_exp_f32 v22, v22
  v_mfma_f32_32x32x16_bf16 v[208:223], v[56:59], v[48:51], v[208:223]
  v_mul_f32 v158, v158, v150
  v_exp_f32 v23, v23
  v_mul_f32 v159, v159, v151
  v_add_f32 v16, 1.0, v16
  s_waitcnt lgkmcnt(2)
  v_mfma_f32_32x32x16_bf16 v[160:175], v[32:35], v[24:27], v[160:175]
  ds_read_b128 v[44:47], v5
  ds_read_b64_tr_b16 v[52:53], v8 offset:2048
  v_add_f32 v17, 1.0, v17
  v_add_f32 v18, 1.0, v18
  v_add_f32 v19, 1.0, v19
  v_mfma_f32_32x32x16_bf16 v[192:207], v[32:35], v[28:31], v[192:207]
  ds_read_b64_tr_b16 v[54:55], v8 offset:2560
  ds_read_b128 v[48:51], v5 offset:4096
  v_add_f32 v20, 1.0, v20
  v_add_f32 v21, 1.0, v21
  v_add_f32 v22, 1.0, v22
  s_waitcnt lgkmcnt(4)
  v_mfma_f32_32x32x16_bf16 v[176:191], v[36:39], v[24:27], v[176:191]
  ds_read_b64_tr_b16 v[56:57], v9 offset:2048
  ds_read_b64_tr_b16 v[58:59], v9 offset:2560
  v_add_f32 v23, 1.0, v23
  v_rcp_f32 v16, v16
  v_mfma_f32_32x32x16_bf16 v[208:223], v[36:39], v[28:31], v[208:223]
  v_rcp_f32 v17, v17
  v_rcp_f32 v18, v18
  v_mul_f32 v152, v152, v16
  s_waitcnt lgkmcnt(2)
  v_mfma_f32_32x32x16_bf16 v[160:175], v[52:55], v[44:47], v[160:175]
  ds_read_b128 v[24:27], v6
  ds_read_b64_tr_b16 v[32:33], v8 offset:4096
  v_rcp_f32 v19, v19
  v_mul_f32 v153, v153, v17
  v_mfma_f32_32x32x16_bf16 v[192:207], v[52:55], v[48:51], v[192:207]
  ds_read_b64_tr_b16 v[34:35], v8 offset:4608
  ds_read_b128 v[28:31], v6 offset:4096
  v_rcp_f32 v20, v20
  v_mul_f32 v154, v154, v18
  s_waitcnt lgkmcnt(4)
  v_mfma_f32_32x32x16_bf16 v[176:191], v[56:59], v[44:47], v[176:191]
  ds_read_b64_tr_b16 v[36:37], v9 offset:4096
  ds_read_b64_tr_b16 v[38:39], v9 offset:4608
  v_rcp_f32 v21, v21
  v_mul_f32 v155, v155, v19
  v_mfma_f32_32x32x16_bf16 v[208:223], v[56:59], v[48:51], v[208:223]
  v_rcp_f32 v22, v22
  v_mul_f32 v156, v156, v20
  v_rcp_f32 v23, v23
  s_waitcnt lgkmcnt(2)
  v_mfma_f32_32x32x16_bf16 v[160:175], v[32:35], v[24:27], v[160:175]
  ds_read_b128 v[44:47], v7
  ds_read_b64_tr_b16 v[52:53], v8 offset:6144
  v_mul_f32 v157, v157, v21
  v_mul_f32 v158, v158, v22
  v_mul_f32 v159, v159, v23
  v_mfma_f32_32x32x16_bf16 v[192:207], v[32:35], v[28:31], v[192:207]
  ds_read_b64_tr_b16 v[54:55], v8 offset:6656
  ds_read_b128 v[48:51], v7 offset:4096
  v_cvt_pk_bf16_f32 v92, v152, v153
  v_cvt_pk_bf16_f32 v93, v154, v155
  v_cvt_pk_bf16_f32 v94, v156, v157
  s_waitcnt lgkmcnt(4)
  v_mfma_f32_32x32x16_bf16 v[176:191], v[36:39], v[24:27], v[176:191]
  ds_read_b64_tr_b16 v[56:57], v9 offset:6144
  ds_read_b64_tr_b16 v[58:59], v9 offset:6656
  v_cvt_pk_bf16_f32 v95, v158, v159
  v_mfma_f32_32x32x16_bf16 v[208:223], v[36:39], v[28:31], v[208:223]
  s_waitcnt lgkmcnt(2)
  v_mfma_f32_32x32x16_bf16 v[160:175], v[52:55], v[44:47], v[160:175]
  s_waitcnt lgkmcnt(0)
  s_mov_b64 exec, 1
  ds_add_u32 v0, v1
  s_mov_b64 exec, -1
  v_mfma_f32_32x32x16_bf16 v[192:207], v[52:55], v[48:51], v[192:207]
  v_mfma_f32_32x32x16_bf16 v[176:191], v[56:59], v[44:47], v[176:191]
  v_mfma_f32_32x32x16_bf16 v[208:223], v[56:59], v[48:51], v[208:223]
K1_GE2:
  v_add_u32 v44, s60, v3
  ds_read_b128 v[40:43], v44
  s_mov_b32 s34, 0xbdd2d3e8
  s_mov_b32 s35, s34
  s_mul_i32 s36, s32, 113
  s_lshl_b32 s37, s22, 3
  s_lshl_b32 s38, s22, 2
  s_add_u32 s38, s38, 44
  s_cmp_lt_u32 s22, 12
  s_cselect_b32 s37, s37, s38
  s_add_u32 s36, s36, s37
  s_lshl_b32 s37, s24, 1
  s_add_u32 s36, s36, s37
  s_lshl_b32 s36, s36, 10
  s_add_u32 s36, s36, 6553600
  s_add_u32 s37, s36, 115712
  s_add_u32 s38, s36, 4096
  s_add_u32 s39, s37, 4096
  s_cmp_lt_u32 s22, 12
  s_cbranch_scc0 K1_GE3
  buffer_store_dwordx4 v[80:83], v3, s[28:31], s36 offen offset:0 sc1
  buffer_store_dwordx4 v[84:87], v3, s[28:31], s36 offen offset:1024 sc1
  buffer_store_dwordx4 v[88:91], v3, s[28:31], s37 offen offset:0 sc1
  buffer_store_dwordx4 v[92:95], v3, s[28:31], s37 offen offset:1024 sc1
K1_GE3:
  v_pk_mul_f32 v[16:17], v[160:161], v[160:161]
  v_pk_mul_f32 v[18:19], v[162:163], v[162:163]
  v_pk_mul_f32 v[20:21], v[164:165], v[164:165]
  v_pk_mul_f32 v[22:23], v[166:167], v[166:167]
  v_pk_fma_f32 v[16:17], v[16:17], s[34:35], v[12:13]
  v_pk_fma_f32 v[18:19], v[18:19], s[34:35], v[12:13]
  v_pk_fma_f32 v[20:21], v[20:21], s[34:35], v[12:13]
  v_pk_fma_f32 v[22:23], v[22:23], s[34:35], v[12:13]
  v_pk_mul_f32 v[16:17], v[16:17], v[160:161]
  v_pk_mul_f32 v[18:19], v[18:19], v[162:163]
  v_pk_mul_f32 v[20:21], v[20:21], v[164:165]
  v_pk_mul_f32 v[22:23], v[22:23], v[166:167]
  v_exp_f32 v16, v16
  v_exp_f32 v17, v17
  v_exp_f32 v18, v18
  v_exp_f32 v19, v19
  v_exp_f32 v20, v20
  v_exp_f32 v21, v21
  v_exp_f32 v22, v22
  v_exp_f32 v23, v23
  v_pk_mul_f32 v[168:169], v[168:169], v[160:161]
  v_pk_mul_f32 v[170:171], v[170:171], v[162:163]
  v_pk_add_f32 v[16:17], v[16:17], v[14:15]
  v_pk_add_f32 v[18:19], v[18:19], v[14:15]
  v_pk_add_f32 v[20:21], v[20:21], v[14:15]
  v_pk_add_f32 v[22:23], v[22:23], v[14:15]
  v_rcp_f32 v16, v16
  v_rcp_f32 v17, v17
  v_rcp_f32 v18, v18
  v_rcp_f32 v19, v19
  v_rcp_f32 v20, v20
  v_rcp_f32 v21, v21
  v_rcp_f32 v22, v22
  v_rcp_f32 v23, v23
  v_pk_mul_f32 v[172:173], v[172:173], v[164:165]
  v_pk_mul_f32 v[174:175], v[174:175], v[166:167]
  v_pk_mul_f32 v[168:169], v[168:169], v[16:17]
  v_pk_mul_f32 v[170:171], v[170:171], v[18:19]
  v_pk_mul_f32 v[172:173], v[172:173], v[20:21]
  v_pk_mul_f32 v[174:175], v[174:175], v[22:23]
  v_cvt_pk_bf16_f32 v64, v168, v169
  v_cvt_pk_bf16_f32 v65, v170, v171
  v_cvt_pk_bf16_f32 v66, v172, v173
  v_cvt_pk_bf16_f32 v67, v174, v175
  buffer_store_dwordx4 v[64:67], v3, s[28:31], s38 offen offset:0 sc1
  v_pk_mul_f32 v[16:17], v[192:193], v[192:193]
  v_pk_mul_f32 v[18:19], v[194:195], v[194:195]
  v_pk_mul_f32 v[20:21], v[196:197], v[196:197]
  v_pk_mul_f32 v[22:23], v[198:199], v[198:199]
  v_pk_fma_f32 v[16:17], v[16:17], s[34:35], v[12:13]
  v_pk_fma_f32 v[18:19], v[18:19], s[34:35], v[12:13]
  v_pk_fma_f32 v[20:21], v[20:21], s[34:35], v[12:13]
  v_pk_fma_f32 v[22:23], v[22:23], s[34:35], v[12:13]
  v_pk_mul_f32 v[16:17], v[16:17], v[192:193]
  v_pk_mul_f32 v[18:19], v[18:19], v[194:195]
  v_pk_mul_f32 v[20:21], v[20:21], v[196:197]
  v_pk_mul_f32 v[22:23], v[22:23], v[198:199]
  v_exp_f32 v16, v16
  v_exp_f32 v17, v17
  v_exp_f32 v18, v18
  v_exp_f32 v19, v19
  v_exp_f32 v20, v20
  v_exp_f32 v21, v21
  v_exp_f32 v22, v22
  v_exp_f32 v23, v23
  v_pk_mul_f32 v[200:201], v[200:201], v[192:193]
  v_pk_mul_f32 v[202:203], v[202:203], v[194:195]
  v_pk_add_f32 v[16:17], v[16:17], v[14:15]
  v_pk_add_f32 v[18:19], v[18:19], v[14:15]
  v_pk_add_f32 v[20:21], v[20:21], v[14:15]
  v_pk_add_f32 v[22:23], v[22:23], v[14:15]
  v_rcp_f32 v16, v16
  v_rcp_f32 v17, v17
  v_rcp_f32 v18, v18
  v_rcp_f32 v19, v19
  v_rcp_f32 v20, v20
  v_rcp_f32 v21, v21
  v_rcp_f32 v22, v22
  v_rcp_f32 v23, v23
  v_pk_mul_f32 v[204:205], v[204:205], v[196:197]
  v_pk_mul_f32 v[206:207], v[206:207], v[198:199]
  v_pk_mul_f32 v[200:201], v[200:201], v[16:17]
  v_pk_mul_f32 v[202:203], v[202:203], v[18:19]
  v_pk_mul_f32 v[204:205], v[204:205], v[20:21]
  v_pk_mul_f32 v[206:207], v[206:207], v[22:23]
  v_cvt_pk_bf16_f32 v72, v200, v201
  v_cvt_pk_bf16_f32 v73, v202, v203
  v_cvt_pk_bf16_f32 v74, v204, v205
  v_cvt_pk_bf16_f32 v75, v206, v207
  buffer_store_dwordx4 v[72:75], v3, s[28:31], s39 offen offset:0 sc1
  v_pk_mul_f32 v[16:17], v[176:177], v[176:177]
  v_pk_mul_f32 v[18:19], v[178:179], v[178:179]
  v_pk_mul_f32 v[20:21], v[180:181], v[180:181]
  v_pk_mul_f32 v[22:23], v[182:183], v[182:183]
  v_pk_fma_f32 v[16:17], v[16:17], s[34:35], v[12:13]
  v_pk_fma_f32 v[18:19], v[18:19], s[34:35], v[12:13]
  v_pk_fma_f32 v[20:21], v[20:21], s[34:35], v[12:13]
  v_pk_fma_f32 v[22:23], v[22:23], s[34:35], v[12:13]
  v_pk_mul_f32 v[16:17], v[16:17], v[176:177]
  v_pk_mul_f32 v[18:19], v[18:19], v[178:179]
  v_pk_mul_f32 v[20:21], v[20:21], v[180:181]
  v_pk_mul_f32 v[22:23], v[22:23], v[182:183]
  v_exp_f32 v16, v16
  v_exp_f32 v17, v17
  v_exp_f32 v18, v18
  v_exp_f32 v19, v19
  v_exp_f32 v20, v20
  v_exp_f32 v21, v21
  v_exp_f32 v22, v22
  v_exp_f32 v23, v23
  v_pk_mul_f32 v[184:185], v[184:185], v[176:177]
  v_pk_mul_f32 v[186:187], v[186:187], v[178:179]
  v_pk_add_f32 v[16:17], v[16:17], v[14:15]
  v_pk_add_f32 v[18:19], v[18:19], v[14:15]
  v_pk_add_f32 v[20:21], v[20:21], v[14:15]
  v_pk_add_f32 v[22:23], v[22:23], v[14:15]
  v_rcp_f32 v16, v16
  v_rcp_f32 v17, v17
  v_rcp_f32 v18, v18
  v_rcp_f32 v19, v19
  v_rcp_f32 v20, v20
  v_rcp_f32 v21, v21
  v_rcp_f32 v22, v22
  v_rcp_f32 v23, v23
  v_pk_mul_f32 v[188:189], v[188:189], v[180:181]
  v_pk_mul_f32 v[190:191], v[190:191], v[182:183]
  v_pk_mul_f32 v[184:185], v[184:185], v[16:17]
  v_pk_mul_f32 v[186:187], v[186:187], v[18:19]
  v_pk_mul_f32 v[188:189], v[188:189], v[20:21]
  v_pk_mul_f32 v[190:191], v[190:191], v[22:23]
  v_cvt_pk_bf16_f32 v68, v184, v185
  v_cvt_pk_bf16_f32 v69, v186, v187
  v_cvt_pk_bf16_f32 v70, v188, v189
  v_cvt_pk_bf16_f32 v71, v190, v191
  buffer_store_dwordx4 v[68:71], v3, s[28:31], s38 offen offset:1024 sc1
  v_pk_mul_f32 v[16:17], v[208:209], v[208:209]
  v_pk_mul_f32 v[18:19], v[210:211], v[210:211]
  v_pk_mul_f32 v[20:21], v[212:213], v[212:213]
  v_pk_mul_f32 v[22:23], v[214:215], v[214:215]
  v_pk_fma_f32 v[16:17], v[16:17], s[34:35], v[12:13]
  v_pk_fma_f32 v[18:19], v[18:19], s[34:35], v[12:13]
  v_pk_fma_f32 v[20:21], v[20:21], s[34:35], v[12:13]
  v_pk_fma_f32 v[22:23], v[22:23], s[34:35], v[12:13]
  v_pk_mul_f32 v[16:17], v[16:17], v[208:209]
  v_pk_mul_f32 v[18:19], v[18:19], v[210:211]
  v_pk_mul_f32 v[20:21], v[20:21], v[212:213]
  v_pk_mul_f32 v[22:23], v[22:23], v[214:215]
  v_exp_f32 v16, v16
  v_exp_f32 v17, v17
  v_exp_f32 v18, v18
  v_exp_f32 v19, v19
  v_exp_f32 v20, v20
  v_exp_f32 v21, v21
  v_exp_f32 v22, v22
  v_exp_f32 v23, v23
  v_pk_mul_f32 v[216:217], v[216:217], v[208:209]
  v_pk_mul_f32 v[218:219], v[218:219], v[210:211]
  v_pk_add_f32 v[16:17], v[16:17], v[14:15]
  v_pk_add_f32 v[18:19], v[18:19], v[14:15]
  v_pk_add_f32 v[20:21], v[20:21], v[14:15]
  v_pk_add_f32 v[22:23], v[22:23], v[14:15]
  v_rcp_f32 v16, v16
  v_rcp_f32 v17, v17
  v_rcp_f32 v18, v18
  v_rcp_f32 v19, v19
  v_rcp_f32 v20, v20
  v_rcp_f32 v21, v21
  v_rcp_f32 v22, v22
  v_rcp_f32 v23, v23
  v_pk_mul_f32 v[220:221], v[220:221], v[212:213]
  v_pk_mul_f32 v[222:223], v[222:223], v[214:215]
  v_pk_mul_f32 v[216:217], v[216:217], v[16:17]
  v_pk_mul_f32 v[218:219], v[218:219], v[18:19]
  v_pk_mul_f32 v[220:221], v[220:221], v[20:21]
  v_pk_mul_f32 v[222:223], v[222:223], v[22:23]
  v_cvt_pk_bf16_f32 v76, v216, v217
  v_cvt_pk_bf16_f32 v77, v218, v219
  v_cvt_pk_bf16_f32 v78, v220, v221
  v_cvt_pk_bf16_f32 v79, v222, v223
  buffer_store_dwordx4 v[76:79], v3, s[28:31], s39 offen offset:1024 sc1
K2_ATTN:
  v_mov_b32 v6, 0xdddd
  v_mov_b32 v36, 0
  v_mov_b32 v37, 0
  v_mov_b32 v38, 0
  v_mov_b32 v39, 0
  s_nop 1
  v_mfma_f32_32x32x16_bf16 v[192:207], v[36:39], v[36:39], 0
  v_mfma_f32_32x32x16_bf16 v[208:223], v[36:39], v[36:39], 0
  v_mfma_f32_32x32x16_bf16 v[176:191], v[36:39], v[36:39], 0
  s_mov_b32 s26, 0
  s_waitcnt lgkmcnt(0)
  v_mov_b32 v7, v40
  v_mov_b32 v40, v3
  s_barrier
  s_setprio 2
  ds_read_b128 v[8:11], v43
  ds_read_b128 v[16:19], v40
  ds_read_b128 v[12:15], v43 offset:1024
  s_waitcnt lgkmcnt(0)
  v_mfma_f32_32x32x16_bf16 v[128:143], v[16:19], v[8:11], 0
  v_mfma_f32_32x32x16_bf16 v[144:159], v[16:19], v[12:15], 0
  s_nop 7
  s_nop 3
  v_max_f32 v44, v128, v129
  v_max3_f32 v44, v130, v131, v44
  v_max3_f32 v44, v132, v133, v44
  v_max3_f32 v44, v134, v135, v44
  v_max3_f32 v44, v136, v137, v44
  v_max3_f32 v44, v138, v139, v44
  v_max3_f32 v44, v140, v141, v44
  v_max3_f32 v44, v142, v143, v44
  v_max_f32 v45, v144, v145
  v_max3_f32 v45, v146, v147, v45
  v_max3_f32 v45, v148, v149, v45
  v_max3_f32 v45, v150, v151, v45
  v_max3_f32 v45, v152, v153, v45
  v_max3_f32 v45, v154, v155, v45
  v_max3_f32 v45, v156, v157, v45
  v_max3_f32 v45, v158, v159, v45
K2_SETMAX:
  ds_read_b128 v[16:19], v40
  ds_read_b128 v[24:27], v41
  ds_read_b128 v[28:31], v42
  ds_read_b128 v[20:23], v40 offset:2080
  v_mov_b32 v46, v44
  v_mov_b32 v47, v45
  s_nop 1
  v_permlane32_swap_b32 v44, v46
  v_permlane32_swap_b32 v45, v47
  v_min_f32 v44, -v44, -v46
  v_min_f32 v45, -v45, -v47
  v_pk_mov_b32 v[96:97], v[44:45], v[44:45] op_sel:[0,0]
  v_pk_mov_b32 v[98:99], v[44:45], v[44:45] op_sel:[0,0]
  v_pk_mov_b32 v[100:101], v[44:45], v[44:45] op_sel:[0,0]
  v_pk_mov_b32 v[102:103], v[44:45], v[44:45] op_sel:[0,0]
  v_pk_mov_b32 v[104:105], v[44:45], v[44:45] op_sel:[0,0]
  v_pk_mov_b32 v[106:107], v[44:45], v[44:45] op_sel:[0,0]
  v_pk_mov_b32 v[108:109], v[44:45], v[44:45] op_sel:[0,0]
  v_pk_mov_b32 v[110:111], v[44:45], v[44:45] op_sel:[0,0]
  s_waitcnt lgkmcnt(0)
  s_nop 0
  v_mfma_f32_32x32x16_bf16 v[128:143], v[16:19], v[8:11], v[96:111]
  v_pk_mov_b32 v[112:113], v[44:45], v[44:45] op_sel:[1,1]
  v_pk_mov_b32 v[114:115], v[44:45], v[44:45] op_sel:[1,1]
  v_pk_mov_b32 v[116:117], v[44:45], v[44:45] op_sel:[1,1]
  v_pk_mov_b32 v[118:119], v[44:45], v[44:45] op_sel:[1,1]
  v_pk_mov_b32 v[120:121], v[44:45], v[44:45] op_sel:[1,1]
  v_pk_mov_b32 v[122:123], v[44:45], v[44:45] op_sel:[1,1]
  v_pk_mov_b32 v[124:125], v[44:45], v[44:45] op_sel:[1,1]
  v_pk_mov_b32 v[126:127], v[44:45], v[44:45] op_sel:[1,1]
  s_nop 3
  s_cmp_lg_u32 s26, 0
  s_cbranch_scc1 K2_NOBAR
  s_waitcnt vmcnt(0)
  s_barrier
K2_NOBAR:
  s_mov_b32 s27, 3
  s_mov_b32 s77, 2
  v_mov_b32 v46, 163604
.p2align 6
K2_LOOP:
  v_mfma_f32_32x32x16_bf16 v[144:159], v[16:19], v[12:15], v[112:127]
  v_exp_f32 v160, v128
  v_exp_f32 v161, v129
  v_exp_f32 v162, v130
  v_exp_f32 v163, v131
  v_exp_f32 v164, v132
  v_smfmac_f32_32x32x32_bf16 v[208:223], v[36:39], v[184:191], v6
  s_waitcnt lgkmcnt(2)
  ds_read_b128 v[32:35], v41 offset:2080
  v_exp_f32 v165, v133
  v_exp_f32 v166, v134
  v_exp_f32 v167, v135
  v_exp_f32 v168, v136
  v_exp_f32 v169, v137
  v_exp_f32 v170, v138
  v_smfmac_f32_32x32x32_bf16 v[192:207], v[24:27], v[160:167], v6
  s_waitcnt lgkmcnt(1)
  ds_read_b128 v[36:39], v42 offset:2080
  v_exp_f32 v171, v139
  v_exp_f32 v172, v140
  v_exp_f32 v173, v141
  v_exp_f32 v174, v142
  v_exp_f32 v175, v143
  v_mfma_f32_32x32x16_bf16 v[128:143], v[20:23], v[8:11], v[96:111]
  ds_read_b128 v[16:19], v40 offset:4160
  v_exp_f32 v176, v144
  v_exp_f32 v177, v145
  v_exp_f32 v178, v146
  v_exp_f32 v179, v147
  v_exp_f32 v180, v148
  v_smfmac_f32_32x32x32_bf16 v[192:207], v[28:31], v[168:175], v6
  v_exp_f32 v181, v149
  v_exp_f32 v182, v150
  v_exp_f32 v183, v151
  v_exp_f32 v184, v152
  v_exp_f32 v185, v153
  v_exp_f32 v186, v154
  v_smfmac_f32_32x32x32_bf16 v[208:223], v[24:27], v[176:183], v6
  v_exp_f32 v187, v155
  v_exp_f32 v188, v156
  v_exp_f32 v189, v157
  v_exp_f32 v190, v158
  v_exp_f32 v191, v159
  v_mfma_f32_32x32x16_bf16 v[144:159], v[20:23], v[12:15], v[112:127]
  v_exp_f32 v160, v128
  v_exp_f32 v161, v129
  v_exp_f32 v162, v130
  v_exp_f32 v163, v131
  v_exp_f32 v164, v132
  v_smfmac_f32_32x32x32_bf16 v[208:223], v[28:31], v[184:191], v6
  s_waitcnt lgkmcnt(2)
  ds_read_b128 v[24:27], v41 offset:4160
  v_exp_f32 v165, v133
  v_exp_f32 v166, v134
  v_exp_f32 v167, v135
  v_exp_f32 v168, v136
  v_exp_f32 v169, v137
  v_exp_f32 v170, v138
  v_smfmac_f32_32x32x32_bf16 v[192:207], v[32:35], v[160:167], v6
  s_waitcnt lgkmcnt(1)
  ds_read_b128 v[28:31], v42 offset:4160
  v_exp_f32 v171, v139
  v_exp_f32 v172, v140
  v_exp_f32 v173, v141
  v_exp_f32 v174, v142
  v_exp_f32 v175, v143
  v_mfma_f32_32x32x16_bf16 v[128:143], v[16:19], v[8:11], v[96:111]
  ds_read_b128 v[20:23], v40 offset:6240
  v_exp_f32 v176, v144
  v_exp_f32 v177, v145
  v_exp_f32 v178, v146
  v_exp_f32 v179, v147
  v_exp_f32 v180, v148
  v_smfmac_f32_32x32x32_bf16 v[192:207], v[36:39], v[168:175], v6
  v_exp_f32 v181, v149
  v_exp_f32 v182, v150
  v_exp_f32 v183, v151
  v_exp_f32 v184, v152
  v_exp_f32 v185, v153
  v_exp_f32 v186, v154
  v_smfmac_f32_32x32x32_bf16 v[208:223], v[32:35], v[176:183], v6
  v_exp_f32 v187, v155
  v_exp_f32 v188, v156
  v_exp_f32 v189, v157
  v_exp_f32 v190, v158
  v_exp_f32 v191, v159
  v_mfma_f32_32x32x16_bf16 v[144:159], v[16:19], v[12:15], v[112:127]
  v_exp_f32 v160, v128
  v_exp_f32 v161, v129
  v_exp_f32 v162, v130
  v_exp_f32 v163, v131
  v_exp_f32 v164, v132
  v_smfmac_f32_32x32x32_bf16 v[208:223], v[36:39], v[184:191], v6
  s_waitcnt lgkmcnt(2)
  ds_read_b128 v[32:35], v41 offset:6240
  v_exp_f32 v165, v133
  v_exp_f32 v166, v134
  v_exp_f32 v167, v135
  v_exp_f32 v168, v136
  v_exp_f32 v169, v137
  v_exp_f32 v170, v138
  v_smfmac_f32_32x32x32_bf16 v[192:207], v[24:27], v[160:167], v6
  s_waitcnt lgkmcnt(1)
  ds_read_b128 v[36:39], v42 offset:6240
  v_exp_f32 v171, v139
  v_exp_f32 v172, v140
  v_exp_f32 v173, v141
  v_exp_f32 v174, v142
  v_exp_f32 v175, v143
  v_mfma_f32_32x32x16_bf16 v[128:143], v[20:23], v[8:11], v[96:111]
  ds_read_b128 v[16:19], v40 offset:8320
  v_exp_f32 v176, v144
  v_exp_f32 v177, v145
  v_exp_f32 v178, v146
  v_exp_f32 v179, v147
  v_exp_f32 v180, v148
  v_smfmac_f32_32x32x32_bf16 v[192:207], v[28:31], v[168:175], v6
  v_exp_f32 v181, v149
  v_exp_f32 v182, v150
  v_exp_f32 v183, v151
  v_exp_f32 v184, v152
  v_exp_f32 v185, v153
  v_exp_f32 v186, v154
  v_smfmac_f32_32x32x32_bf16 v[208:223], v[24:27], v[176:183], v6
  v_exp_f32 v187, v155
  v_exp_f32 v188, v156
  v_exp_f32 v189, v157
  v_exp_f32 v190, v158
  v_exp_f32 v191, v159
  v_mfma_f32_32x32x16_bf16 v[144:159], v[20:23], v[12:15], v[112:127]
  v_exp_f32 v160, v128
  v_exp_f32 v161, v129
  v_exp_f32 v162, v130
  v_exp_f32 v163, v131
  v_exp_f32 v164, v132
  v_smfmac_f32_32x32x32_bf16 v[208:223], v[28:31], v[184:191], v6
  s_waitcnt lgkmcnt(2)
  ds_read_b128 v[24:27], v41 offset:8320
  v_exp_f32 v165, v133
  v_exp_f32 v166, v134
  v_exp_f32 v167, v135
  v_exp_f32 v168, v136
  v_exp_f32 v169, v137
  v_exp_f32 v170, v138
  v_smfmac_f32_32x32x32_bf16 v[192:207], v[32:35], v[160:167], v6
  s_waitcnt lgkmcnt(1)
  ds_read_b128 v[28:31], v42 offset:8320
  v_exp_f32 v171, v139
  v_exp_f32 v172, v140
  v_exp_f32 v173, v141
  v_exp_f32 v174, v142
  v_exp_f32 v175, v143
  v_mfma_f32_32x32x16_bf16 v[128:143], v[16:19], v[8:11], v[96:111]
  ds_read_b128 v[20:23], v40 offset:10400
  v_exp_f32 v176, v144
  v_exp_f32 v177, v145
  v_exp_f32 v178, v146
  v_exp_f32 v179, v147
  v_exp_f32 v180, v148
  v_smfmac_f32_32x32x32_bf16 v[192:207], v[36:39], v[168:175], v6
  v_exp_f32 v181, v149
  v_exp_f32 v182, v150
  v_exp_f32 v183, v151
  v_exp_f32 v184, v152
  v_exp_f32 v185, v153
  v_exp_f32 v186, v154
  v_smfmac_f32_32x32x32_bf16 v[208:223], v[32:35], v[176:183], v6
  v_exp_f32 v187, v155
  v_exp_f32 v188, v156
  v_exp_f32 v189, v157
  v_exp_f32 v190, v158
  v_exp_f32 v191, v159
  v_mfma_f32_32x32x16_bf16 v[144:159], v[16:19], v[12:15], v[112:127]
  v_exp_f32 v160, v128
  v_exp_f32 v161, v129
  v_exp_f32 v162, v130
  v_exp_f32 v163, v131
  v_exp_f32 v164, v132
  v_smfmac_f32_32x32x32_bf16 v[208:223], v[36:39], v[184:191], v6
  s_waitcnt lgkmcnt(2)
  ds_read_b128 v[32:35], v41 offset:10400
  v_exp_f32 v165, v133
  v_exp_f32 v166, v134
  v_exp_f32 v167, v135
  v_exp_f32 v168, v136
  v_exp_f32 v169, v137
  v_exp_f32 v170, v138
  v_smfmac_f32_32x32x32_bf16 v[192:207], v[24:27], v[160:167], v6
  s_waitcnt lgkmcnt(1)
  ds_read_b128 v[36:39], v42 offset:10400
  v_exp_f32 v171, v139
  v_exp_f32 v172, v140
  v_exp_f32 v173, v141
  v_exp_f32 v174, v142
  v_exp_f32 v175, v143
  v_mfma_f32_32x32x16_bf16 v[128:143], v[20:23], v[8:11], v[96:111]
  ds_read_b128 v[16:19], v40 offset:12480
  v_exp_f32 v176, v144
  v_exp_f32 v177, v145
  v_exp_f32 v178, v146
  v_exp_f32 v179, v147
  v_exp_f32 v180, v148
  v_smfmac_f32_32x32x32_bf16 v[192:207], v[28:31], v[168:175], v6
  v_exp_f32 v181, v149
  v_exp_f32 v182, v150
  v_exp_f32 v183, v151
  v_exp_f32 v184, v152
  v_exp_f32 v185, v153
  v_exp_f32 v186, v154
  v_smfmac_f32_32x32x32_bf16 v[208:223], v[24:27], v[176:183], v6
  v_exp_f32 v187, v155
  v_exp_f32 v188, v156
  v_exp_f32 v189, v157
  v_exp_f32 v190, v158
  v_exp_f32 v191, v159
  v_mfma_f32_32x32x16_bf16 v[144:159], v[20:23], v[12:15], v[112:127]
  v_exp_f32 v160, v128
  v_exp_f32 v161, v129
  v_exp_f32 v162, v130
  v_exp_f32 v163, v131
  v_exp_f32 v164, v132
  v_smfmac_f32_32x32x32_bf16 v[208:223], v[28:31], v[184:191], v6
  s_waitcnt lgkmcnt(2)
  ds_read_b128 v[24:27], v41 offset:12480
  v_exp_f32 v165, v133
  v_exp_f32 v166, v134
  v_exp_f32 v167, v135
  v_exp_f32 v168, v136
  v_exp_f32 v169, v137
  v_exp_f32 v170, v138
  v_smfmac_f32_32x32x32_bf16 v[192:207], v[32:35], v[160:167], v6
  s_waitcnt lgkmcnt(1)
  ds_read_b128 v[28:31], v42 offset:12480
  v_exp_f32 v171, v139
  v_exp_f32 v172, v140
  v_exp_f32 v173, v141
  v_exp_f32 v174, v142
  v_exp_f32 v175, v143
  v_mfma_f32_32x32x16_bf16 v[128:143], v[16:19], v[8:11], v[96:111]
  ds_read_b128 v[20:23], v40 offset:14560
  v_exp_f32 v176, v144
  v_exp_f32 v177, v145
  v_exp_f32 v178, v146
  v_exp_f32 v179, v147
  v_exp_f32 v180, v148
  v_smfmac_f32_32x32x32_bf16 v[192:207], v[36:39], v[168:175], v6
  v_exp_f32 v181, v149
  v_exp_f32 v182, v150
  v_exp_f32 v183, v151
  v_exp_f32 v184, v152
  v_exp_f32 v185, v153
  v_exp_f32 v186, v154
  v_smfmac_f32_32x32x32_bf16 v[208:223], v[32:35], v[176:183], v6
  v_exp_f32 v187, v155
  v_exp_f32 v188, v156
  v_exp_f32 v189, v157
  v_exp_f32 v190, v158
  v_exp_f32 v191, v159
  v_mfma_f32_32x32x16_bf16 v[144:159], v[16:19], v[12:15], v[112:127]
  v_exp_f32 v160, v128
  v_exp_f32 v161, v129
  v_exp_f32 v162, v130
  v_exp_f32 v163, v131
  v_exp_f32 v164, v132
  v_smfmac_f32_32x32x32_bf16 v[208:223], v[36:39], v[184:191], v6
  s_waitcnt lgkmcnt(2)
  ds_read_b128 v[32:35], v41 offset:14560
  v_exp_f32 v165, v133
  v_exp_f32 v166, v134
  v_exp_f32 v167, v135
  v_exp_f32 v168, v136
  v_exp_f32 v169, v137
  v_exp_f32 v170, v138
  v_smfmac_f32_32x32x32_bf16 v[192:207], v[24:27], v[160:167], v6
  s_waitcnt lgkmcnt(1)
  ds_read_b128 v[36:39], v42 offset:14560
  v_exp_f32 v171, v139
  v_exp_f32 v172, v140
  v_exp_f32 v173, v141
  v_exp_f32 v174, v142
  v_exp_f32 v175, v143
  v_mfma_f32_32x32x16_bf16 v[128:143], v[20:23], v[8:11], v[96:111]
  ds_read_b128 v[16:19], v40 offset:16640
  v_exp_f32 v176, v144
  v_exp_f32 v177, v145
  v_exp_f32 v178, v146
  v_exp_f32 v179, v147
  v_exp_f32 v180, v148
  v_smfmac_f32_32x32x32_bf16 v[192:207], v[28:31], v[168:175], v6
  ds_read_b32 v47, v46
  v_exp_f32 v181, v149
  v_exp_f32 v182, v150
  v_exp_f32 v183, v151
  v_exp_f32 v184, v152
  v_exp_f32 v185, v153
  v_exp_f32 v186, v154
  v_smfmac_f32_32x32x32_bf16 v[208:223], v[24:27], v[176:183], v6
  v_exp_f32 v187, v155
  v_exp_f32 v188, v156
  v_exp_f32 v189, v157
  v_exp_f32 v190, v158
  v_exp_f32 v191, v159
  v_mfma_f32_32x32x16_bf16 v[144:159], v[20:23], v[12:15], v[112:127]
  v_exp_f32 v160, v128
  v_exp_f32 v161, v129
  v_exp_f32 v162, v130
  v_exp_f32 v163, v131
  v_exp_f32 v164, v132
  v_smfmac_f32_32x32x32_bf16 v[208:223], v[28:31], v[184:191], v6
  s_waitcnt lgkmcnt(2)
  ds_read_b128 v[24:27], v41 offset:16640
  v_exp_f32 v165, v133
  v_exp_f32 v166, v134
  v_exp_f32 v167, v135
  v_exp_f32 v168, v136
  v_exp_f32 v169, v137
  v_exp_f32 v170, v138
  v_smfmac_f32_32x32x32_bf16 v[192:207], v[32:35], v[160:167], v6
  s_waitcnt lgkmcnt(1)
  ds_read_b128 v[28:31], v42 offset:16640
  v_exp_f32 v171, v139
  v_exp_f32 v172, v140
  v_exp_f32 v173, v141
  v_exp_f32 v174, v142
  v_exp_f32 v175, v143
  v_mfma_f32_32x32x16_bf16 v[128:143], v[16:19], v[8:11], v[96:111]
  ds_read_b128 v[20:23], v40 offset:18720
  v_exp_f32 v176, v144
  v_exp_f32 v177, v145
  v_exp_f32 v178, v146
  v_exp_f32 v179, v147
  v_exp_f32 v180, v148
  v_smfmac_f32_32x32x32_bf16 v[192:207], v[36:39], v[168:175], v6
  v_exp_f32 v181, v149
  v_exp_f32 v182, v150
  v_exp_f32 v183, v151
  v_exp_f32 v184, v152
  v_exp_f32 v185, v153
  v_exp_f32 v186, v154
  v_smfmac_f32_32x32x32_bf16 v[208:223], v[32:35], v[176:183], v6
  v_readfirstlane_b32 s75, v47
  v_exp_f32 v187, v155
  v_exp_f32 v188, v156
  v_exp_f32 v189, v157
  v_exp_f32 v190, v158
  v_exp_f32 v191, v159
  v_mfma_f32_32x32x16_bf16 v[144:159], v[16:19], v[12:15], v[112:127]
  s_bitcmp1_b32 s75, s77
  s_cbranch_scc0 K2_KVM
K2_MID:
  v_exp_f32 v160, v128
  v_exp_f32 v161, v129
  v_exp_f32 v162, v130
  v_exp_f32 v163, v131
  v_exp_f32 v164, v132
  v_smfmac_f32_32x32x32_bf16 v[208:223], v[36:39], v[184:191], v6
  s_waitcnt lgkmcnt(2)
  s_add_u32 s77, s77, 4
  s_min_u32 s77, s77, 14
  ds_read_b128 v[32:35], v41 offset:18720
  v_exp_f32 v165, v133
  v_exp_f32 v166, v134
  v_exp_f32 v167, v135
  v_exp_f32 v168, v136
  v_exp_f32 v169, v137
  v_exp_f32 v170, v138
  v_smfmac_f32_32x32x32_bf16 v[192:207], v[24:27], v[160:167], v6
  s_waitcnt lgkmcnt(1)
  ds_read_b128 v[36:39], v42 offset:18720
  v_exp_f32 v171, v139
  v_exp_f32 v172, v140
  v_exp_f32 v173, v141
  v_exp_f32 v174, v142
  v_exp_f32 v175, v143
  v_mfma_f32_32x32x16_bf16 v[128:143], v[20:23], v[8:11], v[96:111]
  ds_read_b128 v[16:19], v40 offset:20800
  v_exp_f32 v176, v144
  v_exp_f32 v177, v145
  v_exp_f32 v178, v146
  v_exp_f32 v179, v147
  v_exp_f32 v180, v148
  v_smfmac_f32_32x32x32_bf16 v[192:207], v[28:31], v[168:175], v6
  v_exp_f32 v181, v149
  v_exp_f32 v182, v150
  v_exp_f32 v183, v151
  v_exp_f32 v184, v152
  v_exp_f32 v185, v153
  v_exp_f32 v186, v154
  v_smfmac_f32_32x32x32_bf16 v[208:223], v[24:27], v[176:183], v6
  v_exp_f32 v187, v155
  v_exp_f32 v188, v156
  v_exp_f32 v189, v157
  v_exp_f32 v190, v158
  v_exp_f32 v191, v159
  v_mfma_f32_32x32x16_bf16 v[144:159], v[20:23], v[12:15], v[112:127]
  v_exp_f32 v160, v128
  v_exp_f32 v161, v129
  v_exp_f32 v162, v130
  v_exp_f32 v163, v131
  v_exp_f32 v164, v132
  v_smfmac_f32_32x32x32_bf16 v[208:223], v[28:31], v[184:191], v6
  s_waitcnt lgkmcnt(2)
  ds_read_b128 v[24:27], v41 offset:20800
  v_exp_f32 v165, v133
  v_exp_f32 v166, v134
  v_exp_f32 v167, v135
  v_exp_f32 v168, v136
  v_exp_f32 v169, v137
  v_exp_f32 v170, v138
  v_smfmac_f32_32x32x32_bf16 v[192:207], v[32:35], v[160:167], v6
  s_waitcnt lgkmcnt(1)
  ds_read_b128 v[28:31], v42 offset:20800
  v_exp_f32 v171, v139
  v_exp_f32 v172, v140
  v_exp_f32 v173, v141
  v_exp_f32 v174, v142
  v_exp_f32 v175, v143
  v_mfma_f32_32x32x16_bf16 v[128:143], v[16:19], v[8:11], v[96:111]
  ds_read_b128 v[20:23], v40 offset:22880
  v_exp_f32 v176, v144
  v_exp_f32 v177, v145
  v_exp_f32 v178, v146
  v_exp_f32 v179, v147
  v_exp_f32 v180, v148
  v_smfmac_f32_32x32x32_bf16 v[192:207], v[36:39], v[168:175], v6
  v_exp_f32 v181, v149
  v_exp_f32 v182, v150
  v_exp_f32 v183, v151
  v_exp_f32 v184, v152
  v_exp_f32 v185, v153
  v_exp_f32 v186, v154
  v_smfmac_f32_32x32x32_bf16 v[208:223], v[32:35], v[176:183], v6
  v_exp_f32 v187, v155
  v_exp_f32 v188, v156
  v_exp_f32 v189, v157
  v_exp_f32 v190, v158
  v_exp_f32 v191, v159
  v_mfma_f32_32x32x16_bf16 v[144:159], v[16:19], v[12:15], v[112:127]
  v_exp_f32 v160, v128
  v_exp_f32 v161, v129
  v_exp_f32 v162, v130
  v_exp_f32 v163, v131
  v_exp_f32 v164, v132
  v_smfmac_f32_32x32x32_bf16 v[208:223], v[36:39], v[184:191], v6
  s_waitcnt lgkmcnt(2)
  ds_read_b128 v[32:35], v41 offset:22880
  v_exp_f32 v165, v133
  v_exp_f32 v166, v134
  v_exp_f32 v167, v135
  v_exp_f32 v168, v136
  v_exp_f32 v169, v137
  v_exp_f32 v170, v138
  v_smfmac_f32_32x32x32_bf16 v[192:207], v[24:27], v[160:167], v6
  s_waitcnt lgkmcnt(1)
  ds_read_b128 v[36:39], v42 offset:22880
  v_exp_f32 v171, v139
  v_exp_f32 v172, v140
  v_exp_f32 v173, v141
  v_exp_f32 v174, v142
  v_exp_f32 v175, v143
  v_mfma_f32_32x32x16_bf16 v[128:143], v[20:23], v[8:11], v[96:111]
  ds_read_b128 v[16:19], v40 offset:24960
  v_exp_f32 v176, v144
  v_exp_f32 v177, v145
  v_exp_f32 v178, v146
  v_exp_f32 v179, v147
  v_exp_f32 v180, v148
  v_smfmac_f32_32x32x32_bf16 v[192:207], v[28:31], v[168:175], v6
  v_exp_f32 v181, v149
  v_exp_f32 v182, v150
  v_exp_f32 v183, v151
  v_exp_f32 v184, v152
  v_exp_f32 v185, v153
  v_exp_f32 v186, v154
  v_smfmac_f32_32x32x32_bf16 v[208:223], v[24:27], v[176:183], v6
  v_exp_f32 v187, v155
  v_exp_f32 v188, v156
  v_exp_f32 v189, v157
  v_exp_f32 v190, v158
  v_exp_f32 v191, v159
  v_mfma_f32_32x32x16_bf16 v[144:159], v[20:23], v[12:15], v[112:127]
  v_exp_f32 v160, v128
  v_exp_f32 v161, v129
  v_exp_f32 v162, v130
  v_exp_f32 v163, v131
  v_exp_f32 v164, v132
  v_smfmac_f32_32x32x32_bf16 v[208:223], v[28:31], v[184:191], v6
  s_waitcnt lgkmcnt(2)
  ds_read_b128 v[24:27], v41 offset:24960
  v_exp_f32 v165, v133
  v_exp_f32 v166, v134
  v_exp_f32 v167, v135
  v_exp_f32 v168, v136
  v_exp_f32 v169, v137
  v_exp_f32 v170, v138
  v_smfmac_f32_32x32x32_bf16 v[192:207], v[32:35], v[160:167], v6
  s_waitcnt lgkmcnt(1)
  ds_read_b128 v[28:31], v42 offset:24960
  v_exp_f32 v171, v139
  v_exp_f32 v172, v140
  v_exp_f32 v173, v141
  v_exp_f32 v174, v142
  v_exp_f32 v175, v143
  v_mfma_f32_32x32x16_bf16 v[128:143], v[16:19], v[8:11], v[96:111]
  ds_read_b128 v[20:23], v40 offset:27040
  v_exp_f32 v176, v144
  v_exp_f32 v177, v145
  v_exp_f32 v178, v146
  v_exp_f32 v179, v147
  v_exp_f32 v180, v148
  v_smfmac_f32_32x32x32_bf16 v[192:207], v[36:39], v[168:175], v6
  v_exp_f32 v181, v149
  v_exp_f32 v182, v150
  v_exp_f32 v183, v151
  v_exp_f32 v184, v152
  v_exp_f32 v185, v153
  v_exp_f32 v186, v154
  v_smfmac_f32_32x32x32_bf16 v[208:223], v[32:35], v[176:183], v6
  v_exp_f32 v187, v155
  v_exp_f32 v188, v156
  v_exp_f32 v189, v157
  v_exp_f32 v190, v158
  v_exp_f32 v191, v159
  v_mfma_f32_32x32x16_bf16 v[144:159], v[16:19], v[12:15], v[112:127]
  v_exp_f32 v160, v128
  v_exp_f32 v161, v129
  v_exp_f32 v162, v130
  v_exp_f32 v163, v131
  v_exp_f32 v164, v132
  v_smfmac_f32_32x32x32_bf16 v[208:223], v[36:39], v[184:191], v6
  s_waitcnt lgkmcnt(2)
  ds_read_b128 v[32:35], v41 offset:27040
  v_exp_f32 v165, v133
  v_exp_f32 v166, v134
  v_exp_f32 v167, v135
  v_exp_f32 v168, v136
  v_exp_f32 v169, v137
  v_exp_f32 v170, v138
  v_smfmac_f32_32x32x32_bf16 v[192:207], v[24:27], v[160:167], v6
  s_waitcnt lgkmcnt(1)
  ds_read_b128 v[36:39], v42 offset:27040
  v_exp_f32 v171, v139
  v_exp_f32 v172, v140
  v_exp_f32 v173, v141
  v_exp_f32 v174, v142
  v_exp_f32 v175, v143
  v_mfma_f32_32x32x16_bf16 v[128:143], v[20:23], v[8:11], v[96:111]
  ds_read_b128 v[16:19], v40 offset:29120
  v_exp_f32 v176, v144
  v_exp_f32 v177, v145
  v_exp_f32 v178, v146
  v_exp_f32 v179, v147
  v_exp_f32 v180, v148
  v_smfmac_f32_32x32x32_bf16 v[192:207], v[28:31], v[168:175], v6
  v_exp_f32 v181, v149
  v_exp_f32 v182, v150
  v_exp_f32 v183, v151
  v_exp_f32 v184, v152
  v_exp_f32 v185, v153
  v_exp_f32 v186, v154
  v_smfmac_f32_32x32x32_bf16 v[208:223], v[24:27], v[176:183], v6
  v_exp_f32 v187, v155
  v_exp_f32 v188, v156
  v_exp_f32 v189, v157
  v_exp_f32 v190, v158
  v_exp_f32 v191, v159
  v_mfma_f32_32x32x16_bf16 v[144:159], v[20:23], v[12:15], v[112:127]
  v_exp_f32 v160, v128
  v_exp_f32 v161, v129
  v_exp_f32 v162, v130
  v_exp_f32 v163, v131
  v_exp_f32 v164, v132
  v_smfmac_f32_32x32x32_bf16 v[208:223], v[28:31], v[184:191], v6
  s_waitcnt lgkmcnt(2)
  ds_read_b128 v[24:27], v41 offset:29120
  v_exp_f32 v165, v133
  v_exp_f32 v166, v134
  v_exp_f32 v167, v135
  v_exp_f32 v168, v136
  v_exp_f32 v169, v137
  v_exp_f32 v170, v138
  v_smfmac_f32_32x32x32_bf16 v[192:207], v[32:35], v[160:167], v6
  s_waitcnt lgkmcnt(1)
  ds_read_b128 v[28:31], v42 offset:29120
  v_exp_f32 v171, v139
  v_exp_f32 v172, v140
  v_exp_f32 v173, v141
  v_exp_f32 v174, v142
  v_exp_f32 v175, v143
  v_mfma_f32_32x32x16_bf16 v[128:143], v[16:19], v[8:11], v[96:111]
  ds_read_b128 v[20:23], v40 offset:31200
  v_exp_f32 v176, v144
  v_exp_f32 v177, v145
  v_exp_f32 v178, v146
  v_exp_f32 v179, v147
  v_exp_f32 v180, v148
  v_smfmac_f32_32x32x32_bf16 v[192:207], v[36:39], v[168:175], v6
  v_exp_f32 v181, v149
  v_exp_f32 v182, v150
  v_exp_f32 v183, v151
  v_exp_f32 v184, v152
  v_exp_f32 v185, v153
  v_exp_f32 v186, v154
  v_smfmac_f32_32x32x32_bf16 v[208:223], v[32:35], v[176:183], v6
  v_exp_f32 v187, v155
  v_exp_f32 v188, v156
  v_exp_f32 v189, v157
  v_exp_f32 v190, v158
  v_exp_f32 v191, v159
  v_mfma_f32_32x32x16_bf16 v[144:159], v[16:19], v[12:15], v[112:127]
  v_exp_f32 v160, v128
  v_exp_f32 v161, v129
  v_exp_f32 v162, v130
  v_exp_f32 v163, v131
  v_exp_f32 v164, v132
  v_smfmac_f32_32x32x32_bf16 v[208:223], v[36:39], v[184:191], v6
  s_waitcnt lgkmcnt(2)
  ds_read_b128 v[32:35], v41 offset:31200
  v_exp_f32 v165, v133
  v_exp_f32 v166, v134
  v_exp_f32 v167, v135
  v_exp_f32 v168, v136
  v_exp_f32 v169, v137
  v_exp_f32 v170, v138
  v_smfmac_f32_32x32x32_bf16 v[192:207], v[24:27], v[160:167], v6
  s_waitcnt lgkmcnt(1)
  ds_read_b128 v[36:39], v42 offset:31200
  v_exp_f32 v171, v139
  v_exp_f32 v172, v140
  v_exp_f32 v173, v141
  v_exp_f32 v174, v142
  v_exp_f32 v175, v143
  v_mfma_f32_32x32x16_bf16 v[128:143], v[20:23], v[8:11], v[96:111]
  ds_read_b128 v[16:19], v40 offset:33280
  v_exp_f32 v176, v144
  v_exp_f32 v177, v145
  v_exp_f32 v178, v146
  v_exp_f32 v179, v147
  v_exp_f32 v180, v148
  v_smfmac_f32_32x32x32_bf16 v[192:207], v[28:31], v[168:175], v6
  ds_read_b32 v47, v46
  v_exp_f32 v181, v149
  v_exp_f32 v182, v150
  v_exp_f32 v183, v151
  v_exp_f32 v184, v152
  v_exp_f32 v185, v153
  v_exp_f32 v186, v154
  v_smfmac_f32_32x32x32_bf16 v[208:223], v[24:27], v[176:183], v6
  v_exp_f32 v187, v155
  v_exp_f32 v188, v156
  v_exp_f32 v189, v157
  v_exp_f32 v190, v158
  v_exp_f32 v191, v159
  v_mfma_f32_32x32x16_bf16 v[144:159], v[20:23], v[12:15], v[112:127]
  v_exp_f32 v160, v128
  v_exp_f32 v161, v129
  v_exp_f32 v162, v130
  v_exp_f32 v163, v131
  v_exp_f32 v164, v132
  v_smfmac_f32_32x32x32_bf16 v[208:223], v[28:31], v[184:191], v6
  s_waitcnt lgkmcnt(2)
  ds_read_b128 v[24:27], v41 offset:33280
  v_exp_f32 v165, v133
  v_exp_f32 v166, v134
  v_exp_f32 v167, v135
  v_exp_f32 v168, v136
  v_exp_f32 v169, v137
  v_exp_f32 v170, v138
  v_smfmac_f32_32x32x32_bf16 v[192:207], v[32:35], v[160:167], v6
  s_waitcnt lgkmcnt(1)
  ds_read_b128 v[28:31], v42 offset:33280
  v_exp_f32 v171, v139
  v_exp_f32 v172, v140
  v_exp_f32 v173, v141
  v_exp_f32 v174, v142
  v_exp_f32 v175, v143
  v_mfma_f32_32x32x16_bf16 v[128:143], v[16:19], v[8:11], v[96:111]
  ds_read_b128 v[20:23], v40 offset:35360
  v_exp_f32 v176, v144
  v_exp_f32 v177, v145
  v_exp_f32 v178, v146
  v_exp_f32 v179, v147
  v_exp_f32 v180, v148
  v_smfmac_f32_32x32x32_bf16 v[192:207], v[36:39], v[168:175], v6
  v_exp_f32 v181, v149
  v_exp_f32 v182, v150
  v_exp_f32 v183, v151
  v_exp_f32 v184, v152
  v_exp_f32 v185, v153
  v_exp_f32 v186, v154
  v_smfmac_f32_32x32x32_bf16 v[208:223], v[32:35], v[176:183], v6
  v_add_u32 v40, 33280, v40
  v_add_u32 v41, 33280, v41
  v_add_u32 v42, 33280, v42
  v_readfirstlane_b32 s75, v47
  v_exp_f32 v187, v155
  v_exp_f32 v188, v156
  v_exp_f32 v189, v157
  v_exp_f32 v190, v158
  v_exp_f32 v191, v159
  s_bitcmp1_b32 s75, s77
  s_cbranch_scc0 K2_KVW
K2_NEXT:
  s_add_u32 s77, s77, 4
  s_min_u32 s77, s77, 14
  s_sub_u32 s27, s27, 1
  s_cbranch_scc0 K2_LOOP
  s_nop 1
  v_smfmac_f32_32x32x32_bf16 v[208:223], v[36:39], v[184:191], v6
  v_mov_b32 v46, 163596
  ds_read_b32 v47, v46
  ds_read_b32 v4, v7
  ds_read_b32 v5, v7 offset:128
  s_lshl_b32 s24, s71, 2
  s_add_u32 s24, s24, s20
  s_lshl_b32 s24, s24, 5
  s_add_u32 s24, s24, s70
  s_lshl_b32 s25, s24, 11
  s_add_u32 s25, s25, 14024704
  v_mov_b32 v48, 0
  v_mov_b32 v49, 0
  v_pk_mul_f32 v[44:45], v[192:193], v[48:49]
  v_pk_fma_f32 v[44:45], v[194:195], v[48:49], v[44:45]
  v_pk_fma_f32 v[44:45], v[196:197], v[48:49], v[44:45]
  v_pk_fma_f32 v[44:45], v[198:199], v[48:49], v[44:45]
  v_pk_fma_f32 v[44:45], v[200:201], v[48:49], v[44:45]
  v_pk_fma_f32 v[44:45], v[208:209], v[48:49], v[44:45]
  v_pk_fma_f32 v[44:45], v[210:211], v[48:49], v[44:45]
  v_pk_fma_f32 v[44:45], v[212:213], v[48:49], v[44:45]
  v_pk_fma_f32 v[44:45], v[214:215], v[48:49], v[44:45]
  v_pk_fma_f32 v[44:45], v[216:217], v[48:49], v[44:45]
  v_mul_f32 v50, 0x61800000, v200
  v_mul_f32 v51, 0x61800000, v216
  v_pk_fma_f32 v[44:45], v[50:51], v[48:49], v[44:45]
  v_cmp_u_f32 vcc, v44, v45
  s_nop 1
  s_cmp_eq_u64 vcc, 0
  s_cbranch_scc0 K2_FB
K2_FIN:
  v_rcp_f32 v48, v200
  v_rcp_f32 v49, v216
  s_mov_b32 s74, 1600000
K2_GW:
  s_waitcnt lgkmcnt(0)
  v_readfirstlane_b32 s75, v47
  s_sub_u32 s74, s74, 1
  s_cmp_eq_u32 s74, 0
  s_cbranch_scc1 K2_GOK
  s_cmp_ge_u32 s75, 64
  s_cbranch_scc1 K2_GOK
  s_sleep 1
  ds_read_b32 v47, v46
  ds_read_b32 v4, v7
  ds_read_b32 v5, v7 offset:128
  s_branch K2_GW
K2_GOK:
  v_mul_f32 v44, v48, v4
  v_mul_f32 v46, v49, v5
  v_mov_b32 v136, s68
  v_mov_b32 v137, s69
  v_mov_b32 v138, s68
  v_mov_b32 v139, s69
  v_pk_mul_f32 v[192:193], v[192:193], v[44:45] op_sel_hi:[1,0]
  v_pk_mul_f32 v[194:195], v[194:195], v[44:45] op_sel_hi:[1,0]
  v_pk_mul_f32 v[196:197], v[196:197], v[44:45] op_sel_hi:[1,0]
  v_pk_mul_f32 v[198:199], v[198:199], v[44:45] op_sel_hi:[1,0]
  v_cvt_pk_bf16_f32 v128, v192, v193
  v_cvt_pk_bf16_f32 v129, v194, v195
  v_cvt_pk_bf16_f32 v130, v196, v197
  v_cvt_pk_bf16_f32 v131, v198, v199
  buffer_store_dwordx4 v[128:131], v3, s[28:31], s25 offen offset:0 sc1
  v_pk_mul_f32 v[208:209], v[208:209], v[46:47] op_sel_hi:[1,0]
  v_pk_mul_f32 v[210:211], v[210:211], v[46:47] op_sel_hi:[1,0]
  v_pk_mul_f32 v[212:213], v[212:213], v[46:47] op_sel_hi:[1,0]
  v_pk_mul_f32 v[214:215], v[214:215], v[46:47] op_sel_hi:[1,0]
  v_cvt_pk_bf16_f32 v132, v208, v209
  v_cvt_pk_bf16_f32 v133, v210, v211
  v_cvt_pk_bf16_f32 v134, v212, v213
  v_cvt_pk_bf16_f32 v135, v214, v215
  buffer_store_dwordx4 v[132:135], v3, s[28:31], s25 offen offset:1024 sc1
  s_lshl_b32 s24, s24, 7
  s_add_u32 s24, s24, 16384000
  s_barrier
  s_waitcnt vmcnt(0)
  s_mov_b64 exec, 1
  buffer_atomic_swap_x2 v[136:137], v3, s[28:31], s24 offen sc1
  s_mov_b64 exec, -1
  s_setprio 0
  s_branch K3_REDUCE
K2_FB:
  s_cmp_lg_u32 s26, 0
  s_cbranch_scc1 K2_FIN
  s_waitcnt lgkmcnt(0)
  s_mov_b32 s26, 100
  v_mov_b32 v40, v3
  v_lshrrev_b32 v43, 5, v2
  v_and_b32 v44, 15, v2
  v_lshlrev_b32 v44, 4, v44
  v_lshl_or_b32 v44, v43, 8, v44
  v_add_u32 v44, 1024, v44
  v_add_u32 v45, 512, v44
  v_and_b32 v43, 31, v2
  v_subrev_u32 v47, 20, v43
  v_cmp_gt_u32 vcc, 8, v47
  v_mov_b32 v46, 2064
  v_mov_b32 v47, 6224
  v_cndmask_b32 v46, v46, v47, vcc
  v_and_b32 v47, 27, v43
  v_cmp_eq_u32 vcc, 16, v47
  v_subrev_u32 v47, 16, v46
  s_nop 0
  v_cndmask_b32 v46, v46, v47, vcc
  v_cmp_gt_u32 vcc, 16, v43
  s_nop 1
  v_cndmask_b32 v41, v46, v44, vcc
  v_cndmask_b32 v42, v46, v45, vcc
  v_mov_b32 v36, 0
  v_mov_b32 v37, 0
  v_mov_b32 v38, 0
  v_mov_b32 v39, 0
  s_nop 1
  v_mfma_f32_32x32x16_bf16 v[192:207], v[36:39], v[36:39], 0
  v_mfma_f32_32x32x16_bf16 v[208:223], v[36:39], v[36:39], 0
  v_mfma_f32_32x32x16_bf16 v[176:191], v[36:39], v[36:39], 0
  v_mov_b32 v44, 0xff800000
  v_mov_b32 v45, 0xff800000
  v_mov_b32 v43, v3
  s_mov_b32 s27, 64
K2_MAXLOOP:
  ds_read_b128 v[16:19], v43
  v_add_u32 v43, 2080, v43
  s_waitcnt lgkmcnt(0)
  v_mfma_f32_32x32x16_bf16 v[128:143], v[16:19], v[8:11], 0
  v_mfma_f32_32x32x16_bf16 v[144:159], v[16:19], v[12:15], 0
  s_nop 7
  s_nop 7
  v_max3_f32 v44, v128, v129, v44
  v_max3_f32 v44, v130, v131, v44
  v_max3_f32 v44, v132, v133, v44
  v_max3_f32 v44, v134, v135, v44
  v_max3_f32 v44, v136, v137, v44
  v_max3_f32 v44, v138, v139, v44
  v_max3_f32 v44, v140, v141, v44
  v_max3_f32 v44, v142, v143, v44
  v_max3_f32 v45, v144, v145, v45
  v_max3_f32 v45, v146, v147, v45
  v_max3_f32 v45, v148, v149, v45
  v_max3_f32 v45, v150, v151, v45
  v_max3_f32 v45, v152, v153, v45
  v_max3_f32 v45, v154, v155, v45
  v_max3_f32 v45, v156, v157, v45
  v_max3_f32 v45, v158, v159, v45
  s_sub_u32 s27, s27, 1
  s_cmp_lg_u32 s27, 0
  s_cbranch_scc1 K2_MAXLOOP
  s_branch K2_SETMAX
SQ_W:
  s_mov_b32 s74, 1600000
  ds_read_b32 v10, v0
LW_13:
  s_waitcnt lgkmcnt(0)
  v_readfirstlane_b32 s75, v10
  s_sub_u32 s74, s74, 1
  s_cbranch_scc1 LWD_14
  s_bitcmp1_b32 s75, 6
  s_cbranch_scc1 LWD_14
  s_sleep 1
  ds_read_b32 v10, v0
  s_branch LW_13
LWD_14:
  s_branch SQ_B
SR_W:
  s_mov_b32 s74, 1600000
  ds_read_b32 v10, v0
LW_15:
  s_waitcnt lgkmcnt(0)
  v_readfirstlane_b32 s75, v10
  s_sub_u32 s74, s74, 1
  s_cbranch_scc1 LWD_16
  s_bitcmp1_b32 s75, 6
  s_cbranch_scc1 LWD_16
  s_sleep 1
  ds_read_b32 v10, v0
  s_branch LW_15
LWD_16:
  s_branch SR_B
K2_KVW:
  s_mov_b32 s74, 1600000
  ds_read_b32 v47, v46
LW_17:
  s_waitcnt lgkmcnt(0)
  v_readfirstlane_b32 s75, v47
  s_sub_u32 s74, s74, 1
  s_cbranch_scc1 LWD_18
  s_bitcmp1_b32 s75, s77
  s_cbranch_scc1 LWD_18
  s_sleep 1
  ds_read_b32 v47, v46
  s_branch LW_17
LWD_18:
  s_branch K2_NEXT
K2_KVM:
  s_mov_b32 s74, 1600000
  ds_read_b32 v47, v46
LW_19:
  s_waitcnt lgkmcnt(0)
  v_readfirstlane_b32 s75, v47
  s_sub_u32 s74, s74, 1
  s_cbranch_scc1 LWD_20
  s_bitcmp1_b32 s75, s77
  s_cbranch_scc1 LWD_20
  s_sleep 1
  ds_read_b32 v47, v46
  s_branch LW_19
LWD_20:
  s_branch K2_MID
K2_GEMM:
  s_mov_b32 s44, s16
  s_mov_b32 s45, s17
  s_mov_b32 s46, 0x1c0000
  s_mov_b32 s47, 0x20000
  s_mov_b32 s48, s8
  s_mov_b32 s49, s9
  s_mov_b32 s50, 0x80000
  s_mov_b32 s51, 0x20000
  s_lshr_b32 s42, s2, 3
  s_and_b32 s43, s42, 7
  s_lshr_b32 s42, s42, 3
  s_lshl_b32 s42, s42, 1
  s_add_u32 s42, s42, s43
  s_cmp_ge_u32 s42, 7
  s_cselect_b32 s43, 7, 0
  s_sub_u32 s42, s42, s43
  s_mov_b32 s52, s42
  s_mul_i32 s32, s23, 28
  s_lshl_b32 s43, s42, 2
  s_add_u32 s32, s32, s43
  s_mul_i32 s33, s72, 231424
  s_add_u32 s33, s33, 6553600
  s_lshl_b32 s43, s32, 10
  s_add_u32 s33, s33, s43
  s_add_u32 s34, s33, 115712
  s_lshl_b32 s43, s73, 7
  s_lshl_b32 s35, s32, 14
  s_add_u32 s35, s35, s43
  s_lshl_b32 s39, s23, 17
  s_add_u32 s39, s39, s43
  s_mul_i32 s53, s23, 6144
  s_add_u32 s53, s53, 137472
  v_mov_b32 v22, 163608
  s_mov_b32 s74, 1600000
  ds_read_b32 v23, v22
LW_21:
  s_waitcnt lgkmcnt(0)
  v_readfirstlane_b32 s75, v23
  s_sub_u32 s74, s74, 1
  s_cbranch_scc1 LWD_22
  s_bitcmp1_b32 s75, 2
  s_cbranch_scc1 LWD_22
  s_sleep 1
  ds_read_b32 v23, v22
  s_branch LW_21
LWD_22:
  ds_write_b128 v36, v[40:43]
  ds_write_b128 v36, v[44:47] offset:16
  ds_write_b128 v36, v[40:43] offset:4160
  ds_write_b128 v36, v[44:47] offset:4176
  s_waitcnt vmcnt(0) lgkmcnt(0)
  s_barrier
  s_setprio 3
  s_mul_i32 s44, s71, 2
  s_lshr_b32 s44, s44, 3
  s_mul_i32 s45, s44, 8320
  s_add_u32 s45, s45, s58
  s_add_u32 m0, s45, 24960
  s_lshl_b32 s37, s44, 12
  s_add_u32 s37, s37, s57
  s_add_u32 s38, s37, 12288
  buffer_load_dwordx4 v3, s[28:31], s38 offen sc1 lds
  s_add_u32 m0, s45, 25984
  s_add_u32 s38, s37, 2174976
  buffer_load_dwordx4 v3, s[28:31], s38 offen sc1 lds
  s_add_u32 s44, s44, 1
  s_cmp_eq_u32 s44, 2
  s_cselect_b32 s44, 0, s44
  s_mul_i32 s45, s44, 8320
  s_add_u32 s45, s45, s58
  s_add_u32 m0, s45, 24960
  s_lshl_b32 s37, s44, 12
  s_add_u32 s37, s37, s57
  s_add_u32 s38, s37, 12288
  buffer_load_dwordx4 v3, s[28:31], s38 offen sc1 lds
  s_add_u32 m0, s45, 25984
  s_add_u32 s38, s37, 2174976
  buffer_load_dwordx4 v3, s[28:31], s38 offen sc1 lds
  s_mul_i32 s44, s71, 2
  s_lshr_b32 s44, s44, 3
  s_mul_i32 s45, s44, 8320
  s_add_u32 s45, s45, s58
  s_add_u32 m0, s45, 41600
  s_lshl_b32 s37, s44, 12
  s_add_u32 s37, s37, s57
  s_add_u32 s38, s37, 20480
  buffer_load_dwordx4 v3, s[28:31], s38 offen sc1 lds
  s_add_u32 m0, s45, 42624
  s_add_u32 s38, s37, 2183168
  buffer_load_dwordx4 v3, s[28:31], s38 offen sc1 lds
  s_add_u32 s44, s44, 1
  s_cmp_eq_u32 s44, 2
  s_cselect_b32 s44, 0, s44
  s_mul_i32 s45, s44, 8320
  s_add_u32 s45, s45, s58
  s_add_u32 m0, s45, 41600
  s_lshl_b32 s37, s44, 12
  s_add_u32 s37, s37, s57
  s_add_u32 s38, s37, 20480
  buffer_load_dwordx4 v3, s[28:31], s38 offen sc1 lds
  s_add_u32 m0, s45, 42624
  s_add_u32 s38, s37, 2183168
  buffer_load_dwordx4 v3, s[28:31], s38 offen sc1 lds
  s_barrier
  s_cmp_lg_u32 s23, 1
  s_cbranch_scc1 K2_NOB1
  s_lshl_b32 s37, s21, 4
  s_add_u32 s37, s37, s22
  s_lshl_b32 s37, s37, 7
  s_add_u32 s37, s37, 16285696
  v_mov_b32 v16, s68
  v_mov_b32 v17, s69
  v_mov_b32 v18, 0
  s_mov_b64 exec, 1
  buffer_store_dwordx2 v[16:17], v18, s[28:31], s37 offen sc1
  s_mov_b64 exec, -1
K2_NOB1:
  s_mul_i32 s44, s71, 2
  s_lshr_b32 s44, s44, 3
  s_mul_i32 s45, s44, 8320
  s_add_u32 s45, s45, s58
  s_add_u32 m0, s45, 58240
  s_lshl_b32 s37, s44, 12
  s_add_u32 s37, s37, s57
  s_add_u32 s38, s37, 28672
  buffer_load_dwordx4 v3, s[28:31], s38 offen sc1 lds
  s_add_u32 m0, s45, 59264
  s_add_u32 s38, s37, 2191360
  buffer_load_dwordx4 v3, s[28:31], s38 offen sc1 lds
  s_add_u32 s44, s44, 1
  s_cmp_eq_u32 s44, 2
  s_cselect_b32 s44, 0, s44
  s_mul_i32 s45, s44, 8320
  s_add_u32 s45, s45, s58
  s_add_u32 m0, s45, 58240
  s_lshl_b32 s37, s44, 12
  s_add_u32 s37, s37, s57
  s_add_u32 s38, s37, 28672
  buffer_load_dwordx4 v3, s[28:31], s38 offen sc1 lds
  s_add_u32 m0, s45, 59264
  s_add_u32 s38, s37, 2191360
  buffer_load_dwordx4 v3, s[28:31], s38 offen sc1 lds
  s_waitcnt vmcnt(8)
  s_mov_b64 exec, 1
  ds_add_u32 v228, v229 offset:12
  s_mov_b64 exec, -1
  s_waitcnt vmcnt(4)
  s_mov_b64 exec, 1
  ds_add_u32 v228, v230 offset:12
  s_mov_b64 exec, -1
  s_mul_i32 s44, s71, 3
  s_lshr_b32 s44, s44, 3
  s_mul_i32 s45, s44, 8320
  s_add_u32 s45, s45, s58
  s_add_u32 m0, s45, 74880
  s_lshl_b32 s37, s44, 12
  s_add_u32 s37, s37, s57
  s_add_u32 s38, s37, 36864
  buffer_load_dwordx4 v3, s[28:31], s38 offen sc1 lds
  s_add_u32 m0, s45, 75904
  s_add_u32 s38, s37, 2199552
  buffer_load_dwordx4 v3, s[28:31], s38 offen sc1 lds
  s_add_u32 s44, s44, 1
  s_cmp_eq_u32 s44, 3
  s_cselect_b32 s44, 0, s44
  s_mul_i32 s45, s44, 8320
  s_add_u32 s45, s45, s58
  s_add_u32 m0, s45, 74880
  s_lshl_b32 s37, s44, 12
  s_add_u32 s37, s37, s57
  s_add_u32 s38, s37, 36864
  buffer_load_dwordx4 v3, s[28:31], s38 offen sc1 lds
  s_add_u32 m0, s45, 75904
  s_add_u32 s38, s37, 2199552
  buffer_load_dwordx4 v3, s[28:31], s38 offen sc1 lds
  s_add_u32 s44, s44, 1
  s_cmp_eq_u32 s44, 3
  s_cselect_b32 s44, 0, s44
  s_mul_i32 s45, s44, 8320
  s_add_u32 s45, s45, s58
  s_add_u32 m0, s45, 74880
  s_lshl_b32 s37, s44, 12
  s_add_u32 s37, s37, s57
  s_add_u32 s38, s37, 36864
  buffer_load_dwordx4 v3, s[28:31], s38 offen sc1 lds
  s_add_u32 m0, s45, 75904
  s_add_u32 s38, s37, 2199552
  buffer_load_dwordx4 v3, s[28:31], s38 offen sc1 lds
  s_waitcnt vmcnt(6)
  s_mov_b64 exec, 1
  ds_add_u32 v228, v231 offset:12
  s_mov_b64 exec, -1
  s_mul_i32 s44, s71, 4
  s_lshr_b32 s44, s44, 3
  s_mul_i32 s45, s44, 8320
  s_add_u32 s45, s45, s58
  s_add_u32 m0, s45, 99840
  s_lshl_b32 s37, s44, 12
  s_add_u32 s37, s37, s57
  s_add_u32 s38, s37, 49152
  buffer_load_dwordx4 v3, s[28:31], s38 offen sc1 lds
  s_add_u32 m0, s45, 100864
  s_add_u32 s38, s37, 2211840
  buffer_load_dwordx4 v3, s[28:31], s38 offen sc1 lds
  s_add_u32 s44, s44, 1
  s_cmp_eq_u32 s44, 4
  s_cselect_b32 s44, 0, s44
  s_mul_i32 s45, s44, 8320
  s_add_u32 s45, s45, s58
  s_add_u32 m0, s45, 99840
  s_lshl_b32 s37, s44, 12
  s_add_u32 s37, s37, s57
  s_add_u32 s38, s37, 49152
  buffer_load_dwordx4 v3, s[28:31], s38 offen sc1 lds
  s_add_u32 m0, s45, 100864
  s_add_u32 s38, s37, 2211840
  buffer_load_dwordx4 v3, s[28:31], s38 offen sc1 lds
  s_add_u32 s44, s44, 1
  s_cmp_eq_u32 s44, 4
  s_cselect_b32 s44, 0, s44
  s_mul_i32 s45, s44, 8320
  s_add_u32 s45, s45, s58
  s_add_u32 m0, s45, 99840
  s_lshl_b32 s37, s44, 12
  s_add_u32 s37, s37, s57
  s_add_u32 s38, s37, 49152
  buffer_load_dwordx4 v3, s[28:31], s38 offen sc1 lds
  s_add_u32 m0, s45, 100864
  s_add_u32 s38, s37, 2211840
  buffer_load_dwordx4 v3, s[28:31], s38 offen sc1 lds
  s_add_u32 s44, s44, 1
  s_cmp_eq_u32 s44, 4
  s_cselect_b32 s44, 0, s44
  s_mul_i32 s45, s44, 8320
  s_add_u32 s45, s45, s58
  s_add_u32 m0, s45, 99840
  s_lshl_b32 s37, s44, 12
  s_add_u32 s37, s37, s57
  s_add_u32 s38, s37, 49152
  buffer_load_dwordx4 v3, s[28:31], s38 offen sc1 lds
  s_add_u32 m0, s45, 100864
  s_add_u32 s38, s37, 2211840
  buffer_load_dwordx4 v3, s[28:31], s38 offen sc1 lds
  s_mov_b32 s44, s16
  s_mov_b32 s45, s17
  s_mov_b32 s46, 0x1c0000
  s_mov_b32 s47, 0x20000
  s_waitcnt vmcnt(0)
  s_mov_b64 exec, 1
  ds_add_u32 v228, v232 offset:12
  s_mov_b64 exec, -1
  s_lshl_b32 s55, s76, 4
  s_add_u32 s55, s55, 16187392
  s_mov_b32 exec_lo, 1
  s_mov_b32 exec_hi, 1
  buffer_store_dwordx2 v[68:69], v70, s[28:31], s55 offen sc1
  s_mov_b64 exec, -1
  s_add_u32 m0, s53, 0
  s_nop 0
  buffer_load_dwordx4 v248, s[44:47], s35 offen lds
  buffer_load_dwordx4 v249, s[44:47], s35 offen offset:1024 lds
  s_add_u32 s35, s35, 16384
  s_add_u32 m0, s53, 2048
  s_nop 0
  buffer_load_dwordx4 v248, s[44:47], s35 offen lds
  buffer_load_dwordx4 v249, s[44:47], s35 offen offset:1024 lds
  s_add_u32 s35, s35, 16384
  s_add_u32 m0, s53, 4096
  s_nop 0
  buffer_load_dwordx4 v248, s[44:47], s35 offen lds
  buffer_load_dwordx4 v249, s[44:47], s35 offen offset:1024 lds
  s_add_u32 s35, s35, 16384
  s_setprio 3
  s_lshr_b32 s24, s72, 1
  s_lshl_b32 s24, s24, 11
  s_add_u32 s24, s24, 16285696
  v_mov_b32 v23, 163592
  s_cmp_lg_u32 s23, 0
  s_cbranch_scc1 PSO_23
  s_mov_b32 s74, 200000
POLL_25:
  buffer_load_dwordx2 v[8:9], v224, s[28:31], s24 offen sc1
  s_waitcnt vmcnt(0)
  v_cmp_ne_u64 vcc, s[68:69], v[8:9]
  s_sub_u32 s74, s74, 1
  s_cmp_eq_u32 s74, 0
  s_cbranch_scc1 POLLD_26
  s_cmp_eq_u64 vcc, 0
  s_cbranch_scc1 POLLD_26
  s_sleep 4
  s_branch POLL_25
POLLD_26:
  v_mov_b32 v20, 3
  ds_write_b32 v23, v20
  s_branch PSD_24
PSO_23:
  s_mov_b32 s74, 1600000
PSL_27:
  ds_read_b32 v20, v23
  s_waitcnt lgkmcnt(0)
  v_readfirstlane_b32 s75, v20
  s_sub_u32 s74, s74, 1
  s_cmp_eq_u32 s74, 0
  s_cbranch_scc1 PSD_24
  s_cmp_ge_u32 s75, 3
  s_cbranch_scc1 PSD_24
  s_sleep 8
  s_branch PSL_27
PSD_24:
  s_lshl_b32 s54, s72, 9
  s_add_u32 s54, s54, 16187392
  s_lshl_b32 s55, s71, 2
  s_add_u32 s55, s55, s23
  s_lshl_b32 s55, s55, 9
  s_add_u32 s55, s55, 16187392
  s_mov_b32 s74, 200000
K2_GL:
  buffer_load_dwordx2 v[240:241], v225, s[28:31], s54 offen sc1
  buffer_load_dwordx2 v[242:243], v225, s[28:31], s54 offen offset:256 sc1
  buffer_load_dwordx2 v[244:245], v226, s[28:31], s55 offen sc1
  s_waitcnt vmcnt(0)
  v_cmp_ne_u32 vcc, s68, v241
  v_cmp_ne_u32 s[56:57], s68, v243
  v_cmp_ne_u32 s[58:59], s68, v245
  s_sub_u32 s74, s74, 1
  s_cbranch_scc1 K2_GD
  s_or_b64 vcc, vcc, s[56:57]
  s_or_b64 vcc, vcc, s[58:59]
  s_cbranch_scc0 K2_GD
  s_sleep 8
  s_branch K2_GL
K2_GD:
  ds_write_b32 v227, v244
  s_mov_b64 exec, 1
  ds_add_u32 v228, v230 offset:4
  s_mov_b64 exec, -1
  s_setprio 0
  buffer_load_dwordx4 v[84:87], v3, s[28:31], s33 offen offset:0 sc1
  buffer_load_dwordx4 v[92:95], v3, s[28:31], s34 offen offset:0 sc1
  buffer_load_dwordx4 v[100:103], v3, s[28:31], s33 offen offset:1024 sc1
  buffer_load_dwordx4 v[108:111], v3, s[28:31], s34 offen offset:1024 sc1
  buffer_load_dwordx4 v[116:119], v3, s[28:31], s33 offen offset:2048 sc1
  buffer_load_dwordx4 v[124:127], v3, s[28:31], s34 offen offset:2048 sc1
  buffer_load_dwordx4 v[132:135], v3, s[28:31], s33 offen offset:3072 sc1
  buffer_load_dwordx4 v[140:143], v3, s[28:31], s34 offen offset:3072 sc1
  s_add_u32 s42, s42, 1
  s_cmp_eq_u32 s42, 7
  s_movk_i32 s43, 4096
  s_cselect_b32 s43, 0xffffa000, s43
  s_cselect_b32 s42, 0, s42
  s_add_u32 s33, s33, s43
  s_add_u32 s34, s34, s43
  s_waitcnt vmcnt(6)
  ds_read_b64_tr_b16 v[80:81], v250 offset:0
  ds_read_b64_tr_b16 v[82:83], v250 offset:1024
  ds_read_b64_tr_b16 v[88:89], v251 offset:0
  ds_read_b64_tr_b16 v[90:91], v251 offset:1024
  s_waitcnt lgkmcnt(0)
  s_add_u32 m0, s53, 0
  s_nop 0
  buffer_load_dwordx4 v248, s[44:47], s35 offen lds
  buffer_load_dwordx4 v249, s[44:47], s35 offen offset:1024 lds
  s_add_u32 s35, s35, 16384
  s_add_u32 s52, s52, 1
  s_cmp_eq_u32 s52, 7
  s_cselect_b32 s43, 0xfff90000, 0
  s_cselect_b32 s52, 0, s52
  s_add_u32 s35, s35, s43
  buffer_load_dwordx4 v[148:151], v3, s[28:31], s33 offen offset:0 sc1
  buffer_load_dwordx4 v[156:159], v3, s[28:31], s34 offen offset:0 sc1
  v_mfma_f32_32x32x16_bf16 v[16:31], v[80:83], v[84:87], 0
  v_mfma_f32_32x32x16_bf16 v[32:47], v[80:83], v[92:95], 0
  v_mfma_f32_32x32x16_bf16 v[48:63], v[88:91], v[84:87], 0
  v_mfma_f32_32x32x16_bf16 v[64:79], v[88:91], v[92:95], 0
  s_waitcnt vmcnt(8)
  ds_read_b64_tr_b16 v[96:97], v250 offset:2048
  ds_read_b64_tr_b16 v[98:99], v250 offset:3072
  ds_read_b64_tr_b16 v[104:105], v251 offset:2048
  ds_read_b64_tr_b16 v[106:107], v251 offset:3072
  s_waitcnt lgkmcnt(0)
  s_add_u32 m0, s53, 2048
  s_nop 0
  buffer_load_dwordx4 v248, s[44:47], s35 offen lds
  buffer_load_dwordx4 v249, s[44:47], s35 offen offset:1024 lds
  s_add_u32 s35, s35, 16384
  buffer_load_dwordx4 v[164:167], v3, s[28:31], s33 offen offset:1024 sc1
  buffer_load_dwordx4 v[172:175], v3, s[28:31], s34 offen offset:1024 sc1
  v_mfma_f32_32x32x16_bf16 v[16:31], v[96:99], v[100:103], v[16:31]
  v_mfma_f32_32x32x16_bf16 v[32:47], v[96:99], v[108:111], v[32:47]
  v_mfma_f32_32x32x16_bf16 v[48:63], v[104:107], v[100:103], v[48:63]
  v_mfma_f32_32x32x16_bf16 v[64:79], v[104:107], v[108:111], v[64:79]
  s_waitcnt vmcnt(10)
  ds_read_b64_tr_b16 v[112:113], v250 offset:4096
  ds_read_b64_tr_b16 v[114:115], v250 offset:5120
  ds_read_b64_tr_b16 v[120:121], v251 offset:4096
  ds_read_b64_tr_b16 v[122:123], v251 offset:5120
  s_waitcnt lgkmcnt(0)
  s_add_u32 m0, s53, 4096
  s_nop 0
  buffer_load_dwordx4 v248, s[44:47], s35 offen lds
  buffer_load_dwordx4 v249, s[44:47], s35 offen offset:1024 lds
  s_add_u32 s35, s35, 16384
  buffer_load_dwordx4 v[180:183], v3, s[28:31], s33 offen offset:2048 sc1
  buffer_load_dwordx4 v[188:191], v3, s[28:31], s34 offen offset:2048 sc1
  v_mfma_f32_32x32x16_bf16 v[16:31], v[112:115], v[116:119], v[16:31]
  v_mfma_f32_32x32x16_bf16 v[32:47], v[112:115], v[124:127], v[32:47]
  v_mfma_f32_32x32x16_bf16 v[48:63], v[120:123], v[116:119], v[48:63]
  v_mfma_f32_32x32x16_bf16 v[64:79], v[120:123], v[124:127], v[64:79]
  s_waitcnt vmcnt(10)
  ds_read_b64_tr_b16 v[128:129], v250 offset:0
  ds_read_b64_tr_b16 v[130:131], v250 offset:1024
  ds_read_b64_tr_b16 v[136:137], v251 offset:0
  ds_read_b64_tr_b16 v[138:139], v251 offset:1024
  s_waitcnt lgkmcnt(0)
  s_add_u32 m0, s53, 0
  s_nop 0
  buffer_load_dwordx4 v248, s[44:47], s35 offen lds
  buffer_load_dwordx4 v249, s[44:47], s35 offen offset:1024 lds
  s_add_u32 s35, s35, 16384
  buffer_load_dwordx4 v[196:199], v3, s[28:31], s33 offen offset:3072 sc1
  buffer_load_dwordx4 v[204:207], v3, s[28:31], s34 offen offset:3072 sc1
  s_add_u32 s42, s42, 1
  s_cmp_eq_u32 s42, 7
  s_movk_i32 s43, 4096
  s_cselect_b32 s43, 0xffffa000, s43
  s_cselect_b32 s42, 0, s42
  s_add_u32 s33, s33, s43
  s_add_u32 s34, s34, s43
  v_mfma_f32_32x32x16_bf16 v[16:31], v[128:131], v[132:135], v[16:31]
  v_mfma_f32_32x32x16_bf16 v[32:47], v[128:131], v[140:143], v[32:47]
  v_mfma_f32_32x32x16_bf16 v[48:63], v[136:139], v[132:135], v[48:63]
  v_mfma_f32_32x32x16_bf16 v[64:79], v[136:139], v[140:143], v[64:79]
  s_waitcnt vmcnt(10)
  ds_read_b64_tr_b16 v[144:145], v250 offset:2048
  ds_read_b64_tr_b16 v[146:147], v250 offset:3072
  ds_read_b64_tr_b16 v[152:153], v251 offset:2048
  ds_read_b64_tr_b16 v[154:155], v251 offset:3072
  s_waitcnt lgkmcnt(0)
  s_add_u32 m0, s53, 2048
  s_nop 0
  buffer_load_dwordx4 v248, s[44:47], s35 offen lds
  buffer_load_dwordx4 v249, s[44:47], s35 offen offset:1024 lds
  s_add_u32 s35, s35, 16384
  s_add_u32 s52, s52, 1
  s_cmp_eq_u32 s52, 7
  s_cselect_b32 s43, 0xfff90000, 0
  s_cselect_b32 s52, 0, s52
  s_add_u32 s35, s35, s43
  buffer_load_dwordx4 v[84:87], v3, s[28:31], s33 offen offset:0 sc1
  buffer_load_dwordx4 v[92:95], v3, s[28:31], s34 offen offset:0 sc1
  v_mfma_f32_32x32x16_bf16 v[16:31], v[144:147], v[148:151], v[16:31]
  v_mfma_f32_32x32x16_bf16 v[32:47], v[144:147], v[156:159], v[32:47]
  v_mfma_f32_32x32x16_bf16 v[48:63], v[152:155], v[148:151], v[48:63]
  v_mfma_f32_32x32x16_bf16 v[64:79], v[152:155], v[156:159], v[64:79]
  s_waitcnt vmcnt(10)
  ds_read_b64_tr_b16 v[160:161], v250 offset:4096
  ds_read_b64_tr_b16 v[162:163], v250 offset:5120
  ds_read_b64_tr_b16 v[168:169], v251 offset:4096
  ds_read_b64_tr_b16 v[170:171], v251 offset:5120
  s_waitcnt lgkmcnt(0)
  s_add_u32 m0, s53, 4096
  s_nop 0
  buffer_load_dwordx4 v248, s[44:47], s35 offen lds
  buffer_load_dwordx4 v249, s[44:47], s35 offen offset:1024 lds
  s_add_u32 s35, s35, 16384
  buffer_load_dwordx4 v[100:103], v3, s[28:31], s33 offen offset:1024 sc1
  buffer_load_dwordx4 v[108:111], v3, s[28:31], s34 offen offset:1024 sc1
  v_mfma_f32_32x32x16_bf16 v[16:31], v[160:163], v[164:167], v[16:31]
  v_mfma_f32_32x32x16_bf16 v[32:47], v[160:163], v[172:175], v[32:47]
  v_mfma_f32_32x32x16_bf16 v[48:63], v[168:171], v[164:167], v[48:63]
  v_mfma_f32_32x32x16_bf16 v[64:79], v[168:171], v[172:175], v[64:79]
  s_waitcnt vmcnt(10)
  ds_read_b64_tr_b16 v[176:177], v250 offset:0
  ds_read_b64_tr_b16 v[178:179], v250 offset:1024
  ds_read_b64_tr_b16 v[184:185], v251 offset:0
  ds_read_b64_tr_b16 v[186:187], v251 offset:1024
  s_waitcnt lgkmcnt(0)
  s_add_u32 m0, s53, 0
  s_nop 0
  buffer_load_dwordx4 v248, s[44:47], s35 offen lds
  buffer_load_dwordx4 v249, s[44:47], s35 offen offset:1024 lds
  s_add_u32 s35, s35, 16384
  buffer_load_dwordx4 v[116:119], v3, s[28:31], s33 offen offset:2048 sc1
  buffer_load_dwordx4 v[124:127], v3, s[28:31], s34 offen offset:2048 sc1
  v_mfma_f32_32x32x16_bf16 v[16:31], v[176:179], v[180:183], v[16:31]
  v_mfma_f32_32x32x16_bf16 v[32:47], v[176:179], v[188:191], v[32:47]
  v_mfma_f32_32x32x16_bf16 v[48:63], v[184:187], v[180:183], v[48:63]
  v_mfma_f32_32x32x16_bf16 v[64:79], v[184:187], v[188:191], v[64:79]
  s_waitcnt vmcnt(10)
  ds_read_b64_tr_b16 v[192:193], v250 offset:2048
  ds_read_b64_tr_b16 v[194:195], v250 offset:3072
  ds_read_b64_tr_b16 v[200:201], v251 offset:2048
  ds_read_b64_tr_b16 v[202:203], v251 offset:3072
  s_waitcnt lgkmcnt(0)
  s_add_u32 m0, s53, 2048
  s_nop 0
  buffer_load_dwordx4 v248, s[44:47], s35 offen lds
  buffer_load_dwordx4 v249, s[44:47], s35 offen offset:1024 lds
  s_add_u32 s35, s35, 16384
  buffer_load_dwordx4 v[132:135], v3, s[28:31], s33 offen offset:3072 sc1
  buffer_load_dwordx4 v[140:143], v3, s[28:31], s34 offen offset:3072 sc1
  s_add_u32 s42, s42, 1
  s_cmp_eq_u32 s42, 7
  s_movk_i32 s43, 4096
  s_cselect_b32 s43, 0xffffa000, s43
  s_cselect_b32 s42, 0, s42
  s_add_u32 s33, s33, s43
  s_add_u32 s34, s34, s43
  v_mfma_f32_32x32x16_bf16 v[16:31], v[192:195], v[196:199], v[16:31]
  v_mfma_f32_32x32x16_bf16 v[32:47], v[192:195], v[204:207], v[32:47]
  v_mfma_f32_32x32x16_bf16 v[48:63], v[200:203], v[196:199], v[48:63]
  v_mfma_f32_32x32x16_bf16 v[64:79], v[200:203], v[204:207], v[64:79]
  s_waitcnt vmcnt(10)
  ds_read_b64_tr_b16 v[80:81], v250 offset:4096
  ds_read_b64_tr_b16 v[82:83], v250 offset:5120
  ds_read_b64_tr_b16 v[88:89], v251 offset:4096
  ds_read_b64_tr_b16 v[90:91], v251 offset:5120
  s_waitcnt lgkmcnt(0)
  s_add_u32 m0, s53, 4096
  s_nop 0
  buffer_load_dwordx4 v248, s[44:47], s35 offen lds
  buffer_load_dwordx4 v249, s[44:47], s35 offen offset:1024 lds
  s_add_u32 s35, s35, 16384
  s_add_u32 s52, s52, 1
  s_cmp_eq_u32 s52, 7
  s_cselect_b32 s43, 0xfff90000, 0
  s_cselect_b32 s52, 0, s52
  s_add_u32 s35, s35, s43
  buffer_load_dwordx4 v[148:151], v3, s[28:31], s33 offen offset:0 sc1
  buffer_load_dwordx4 v[156:159], v3, s[28:31], s34 offen offset:0 sc1
  v_mfma_f32_32x32x16_bf16 v[16:31], v[80:83], v[84:87], v[16:31]
  v_mfma_f32_32x32x16_bf16 v[32:47], v[80:83], v[92:95], v[32:47]
  v_mfma_f32_32x32x16_bf16 v[48:63], v[88:91], v[84:87], v[48:63]
  v_mfma_f32_32x32x16_bf16 v[64:79], v[88:91], v[92:95], v[64:79]
  s_waitcnt vmcnt(10)
  ds_read_b64_tr_b16 v[96:97], v250 offset:0
  ds_read_b64_tr_b16 v[98:99], v250 offset:1024
  ds_read_b64_tr_b16 v[104:105], v251 offset:0
  ds_read_b64_tr_b16 v[106:107], v251 offset:1024
  s_waitcnt lgkmcnt(0)
  s_add_u32 m0, s53, 0
  s_nop 0
  buffer_load_dwordx4 v248, s[44:47], s35 offen lds
  buffer_load_dwordx4 v249, s[44:47], s35 offen offset:1024 lds
  s_add_u32 s35, s35, 16384
  buffer_load_dwordx4 v[164:167], v3, s[28:31], s33 offen offset:1024 sc1
  buffer_load_dwordx4 v[172:175], v3, s[28:31], s34 offen offset:1024 sc1
  v_mfma_f32_32x32x16_bf16 v[16:31], v[96:99], v[100:103], v[16:31]
  v_mfma_f32_32x32x16_bf16 v[32:47], v[96:99], v[108:111], v[32:47]
  v_mfma_f32_32x32x16_bf16 v[48:63], v[104:107], v[100:103], v[48:63]
  v_mfma_f32_32x32x16_bf16 v[64:79], v[104:107], v[108:111], v[64:79]
  s_waitcnt vmcnt(10)
  ds_read_b64_tr_b16 v[112:113], v250 offset:2048
  ds_read_b64_tr_b16 v[114:115], v250 offset:3072
  ds_read_b64_tr_b16 v[120:121], v251 offset:2048
  ds_read_b64_tr_b16 v[122:123], v251 offset:3072
  s_waitcnt lgkmcnt(0)
  s_add_u32 m0, s53, 2048
  s_nop 0
  buffer_load_dwordx4 v248, s[44:47], s35 offen lds
  buffer_load_dwordx4 v249, s[44:47], s35 offen offset:1024 lds
  s_add_u32 s35, s35, 16384
  buffer_load_dwordx4 v[180:183], v3, s[28:31], s33 offen offset:2048 sc1
  buffer_load_dwordx4 v[188:191], v3, s[28:31], s34 offen offset:2048 sc1
  v_mfma_f32_32x32x16_bf16 v[16:31], v[112:115], v[116:119], v[16:31]
  v_mfma_f32_32x32x16_bf16 v[32:47], v[112:115], v[124:127], v[32:47]
  v_mfma_f32_32x32x16_bf16 v[48:63], v[120:123], v[116:119], v[48:63]
  v_mfma_f32_32x32x16_bf16 v[64:79], v[120:123], v[124:127], v[64:79]
  s_waitcnt vmcnt(10)
  ds_read_b64_tr_b16 v[128:129], v250 offset:4096
  ds_read_b64_tr_b16 v[130:131], v250 offset:5120
  ds_read_b64_tr_b16 v[136:137], v251 offset:4096
  ds_read_b64_tr_b16 v[138:139], v251 offset:5120
  s_waitcnt lgkmcnt(0)
  s_add_u32 m0, s53, 4096
  s_nop 0
  buffer_load_dwordx4 v248, s[44:47], s35 offen lds
  buffer_load_dwordx4 v249, s[44:47], s35 offen offset:1024 lds
  s_add_u32 s35, s35, 16384
  buffer_load_dwordx4 v[196:199], v3, s[28:31], s33 offen offset:3072 sc1
  buffer_load_dwordx4 v[204:207], v3, s[28:31], s34 offen offset:3072 sc1
  s_add_u32 s42, s42, 1
  s_cmp_eq_u32 s42, 7
  s_movk_i32 s43, 4096
  s_cselect_b32 s43, 0xffffa000, s43
  s_cselect_b32 s42, 0, s42
  s_add_u32 s33, s33, s43
  s_add_u32 s34, s34, s43
  v_mfma_f32_32x32x16_bf16 v[16:31], v[128:131], v[132:135], v[16:31]
  v_mfma_f32_32x32x16_bf16 v[32:47], v[128:131], v[140:143], v[32:47]
  v_mfma_f32_32x32x16_bf16 v[48:63], v[136:139], v[132:135], v[48:63]
  v_mfma_f32_32x32x16_bf16 v[64:79], v[136:139], v[140:143], v[64:79]
  s_waitcnt vmcnt(10)
  ds_read_b64_tr_b16 v[144:145], v250 offset:0
  ds_read_b64_tr_b16 v[146:147], v250 offset:1024
  ds_read_b64_tr_b16 v[152:153], v251 offset:0
  ds_read_b64_tr_b16 v[154:155], v251 offset:1024
  s_waitcnt lgkmcnt(0)
  s_add_u32 m0, s53, 0
  s_nop 0
  buffer_load_dwordx4 v248, s[44:47], s35 offen lds
  buffer_load_dwordx4 v249, s[44:47], s35 offen offset:1024 lds
  s_add_u32 s35, s35, 16384
  s_add_u32 s52, s52, 1
  s_cmp_eq_u32 s52, 7
  s_cselect_b32 s43, 0xfff90000, 0
  s_cselect_b32 s52, 0, s52
  s_add_u32 s35, s35, s43
  buffer_load_dwordx4 v[84:87], v3, s[28:31], s33 offen offset:0 sc1
  buffer_load_dwordx4 v[92:95], v3, s[28:31], s34 offen offset:0 sc1
  v_mfma_f32_32x32x16_bf16 v[16:31], v[144:147], v[148:151], v[16:31]
  v_mfma_f32_32x32x16_bf16 v[32:47], v[144:147], v[156:159], v[32:47]
  v_mfma_f32_32x32x16_bf16 v[48:63], v[152:155], v[148:151], v[48:63]
  v_mfma_f32_32x32x16_bf16 v[64:79], v[152:155], v[156:159], v[64:79]
  s_waitcnt vmcnt(10)
  ds_read_b64_tr_b16 v[160:161], v250 offset:2048
  ds_read_b64_tr_b16 v[162:163], v250 offset:3072
  ds_read_b64_tr_b16 v[168:169], v251 offset:2048
  ds_read_b64_tr_b16 v[170:171], v251 offset:3072
  s_waitcnt lgkmcnt(0)
  s_add_u32 m0, s53, 2048
  s_nop 0
  buffer_load_dwordx4 v248, s[44:47], s35 offen lds
  buffer_load_dwordx4 v249, s[44:47], s35 offen offset:1024 lds
  s_add_u32 s35, s35, 16384
  buffer_load_dwordx4 v[100:103], v3, s[28:31], s33 offen offset:1024 sc1
  buffer_load_dwordx4 v[108:111], v3, s[28:31], s34 offen offset:1024 sc1
  v_mfma_f32_32x32x16_bf16 v[16:31], v[160:163], v[164:167], v[16:31]
  v_mfma_f32_32x32x16_bf16 v[32:47], v[160:163], v[172:175], v[32:47]
  v_mfma_f32_32x32x16_bf16 v[48:63], v[168:171], v[164:167], v[48:63]
  v_mfma_f32_32x32x16_bf16 v[64:79], v[168:171], v[172:175], v[64:79]
  s_waitcnt vmcnt(10)
  ds_read_b64_tr_b16 v[176:177], v250 offset:4096
  ds_read_b64_tr_b16 v[178:179], v250 offset:5120
  ds_read_b64_tr_b16 v[184:185], v251 offset:4096
  ds_read_b64_tr_b16 v[186:187], v251 offset:5120
  s_waitcnt lgkmcnt(0)
  s_add_u32 m0, s53, 4096
  s_nop 0
  buffer_load_dwordx4 v248, s[44:47], s35 offen lds
  buffer_load_dwordx4 v249, s[44:47], s35 offen offset:1024 lds
  s_add_u32 s35, s35, 16384
  buffer_load_dwordx4 v[116:119], v3, s[28:31], s33 offen offset:2048 sc1
  buffer_load_dwordx4 v[124:127], v3, s[28:31], s34 offen offset:2048 sc1
  v_mfma_f32_32x32x16_bf16 v[16:31], v[176:179], v[180:183], v[16:31]
  v_mfma_f32_32x32x16_bf16 v[32:47], v[176:179], v[188:191], v[32:47]
  v_mfma_f32_32x32x16_bf16 v[48:63], v[184:187], v[180:183], v[48:63]
  v_mfma_f32_32x32x16_bf16 v[64:79], v[184:187], v[188:191], v[64:79]
  s_waitcnt vmcnt(10)
  ds_read_b64_tr_b16 v[192:193], v250 offset:0
  ds_read_b64_tr_b16 v[194:195], v250 offset:1024
  ds_read_b64_tr_b16 v[200:201], v251 offset:0
  ds_read_b64_tr_b16 v[202:203], v251 offset:1024
  s_waitcnt lgkmcnt(0)
  s_add_u32 m0, s53, 0
  s_nop 0
  buffer_load_dwordx4 v248, s[44:47], s35 offen lds
  buffer_load_dwordx4 v249, s[44:47], s35 offen offset:1024 lds
  s_add_u32 s35, s35, 16384
  buffer_load_dwordx4 v[132:135], v3, s[28:31], s33 offen offset:3072 sc1
  buffer_load_dwordx4 v[140:143], v3, s[28:31], s34 offen offset:3072 sc1
  s_add_u32 s42, s42, 1
  s_cmp_eq_u32 s42, 7
  s_movk_i32 s43, 4096
  s_cselect_b32 s43, 0xffffa000, s43
  s_cselect_b32 s42, 0, s42
  s_add_u32 s33, s33, s43
  s_add_u32 s34, s34, s43
  v_mfma_f32_32x32x16_bf16 v[16:31], v[192:195], v[196:199], v[16:31]
  v_mfma_f32_32x32x16_bf16 v[32:47], v[192:195], v[204:207], v[32:47]
  v_mfma_f32_32x32x16_bf16 v[48:63], v[200:203], v[196:199], v[48:63]
  v_mfma_f32_32x32x16_bf16 v[64:79], v[200:203], v[204:207], v[64:79]
  s_waitcnt vmcnt(10)
  ds_read_b64_tr_b16 v[80:81], v250 offset:2048
  ds_read_b64_tr_b16 v[82:83], v250 offset:3072
  ds_read_b64_tr_b16 v[88:89], v251 offset:2048
  ds_read_b64_tr_b16 v[90:91], v251 offset:3072
  s_waitcnt lgkmcnt(0)
  s_add_u32 m0, s53, 2048
  s_nop 0
  buffer_load_dwordx4 v248, s[44:47], s35 offen lds
  buffer_load_dwordx4 v249, s[44:47], s35 offen offset:1024 lds
  s_add_u32 s35, s35, 16384
  s_add_u32 s52, s52, 1
  s_cmp_eq_u32 s52, 7
  s_cselect_b32 s43, 0xfff90000, 0
  s_cselect_b32 s52, 0, s52
  s_add_u32 s35, s35, s43
  buffer_load_dwordx4 v[148:151], v3, s[28:31], s33 offen offset:0 sc1
  buffer_load_dwordx4 v[156:159], v3, s[28:31], s34 offen offset:0 sc1
  v_mfma_f32_32x32x16_bf16 v[16:31], v[80:83], v[84:87], v[16:31]
  v_mfma_f32_32x32x16_bf16 v[32:47], v[80:83], v[92:95], v[32:47]
  v_mfma_f32_32x32x16_bf16 v[48:63], v[88:91], v[84:87], v[48:63]
  v_mfma_f32_32x32x16_bf16 v[64:79], v[88:91], v[92:95], v[64:79]
  s_waitcnt vmcnt(10)
  ds_read_b64_tr_b16 v[96:97], v250 offset:4096
  ds_read_b64_tr_b16 v[98:99], v250 offset:5120
  ds_read_b64_tr_b16 v[104:105], v251 offset:4096
  ds_read_b64_tr_b16 v[106:107], v251 offset:5120
  s_waitcnt lgkmcnt(0)
  s_add_u32 m0, s53, 4096
  s_nop 0
  buffer_load_dwordx4 v248, s[44:47], s35 offen lds
  buffer_load_dwordx4 v249, s[44:47], s35 offen offset:1024 lds
  s_add_u32 s35, s35, 16384
  buffer_load_dwordx4 v[164:167], v3, s[28:31], s33 offen offset:1024 sc1
  buffer_load_dwordx4 v[172:175], v3, s[28:31], s34 offen offset:1024 sc1
  v_mfma_f32_32x32x16_bf16 v[16:31], v[96:99], v[100:103], v[16:31]
  v_mfma_f32_32x32x16_bf16 v[32:47], v[96:99], v[108:111], v[32:47]
  v_mfma_f32_32x32x16_bf16 v[48:63], v[104:107], v[100:103], v[48:63]
  v_mfma_f32_32x32x16_bf16 v[64:79], v[104:107], v[108:111], v[64:79]
  s_waitcnt vmcnt(10)
  ds_read_b64_tr_b16 v[112:113], v250 offset:0
  ds_read_b64_tr_b16 v[114:115], v250 offset:1024
  ds_read_b64_tr_b16 v[120:121], v251 offset:0
  ds_read_b64_tr_b16 v[122:123], v251 offset:1024
  s_waitcnt lgkmcnt(0)
  s_add_u32 m0, s53, 0
  s_nop 0
  buffer_load_dwordx4 v248, s[44:47], s35 offen lds
  buffer_load_dwordx4 v249, s[44:47], s35 offen offset:1024 lds
  s_add_u32 s35, s35, 16384
  buffer_load_dwordx4 v[180:183], v3, s[28:31], s33 offen offset:2048 sc1
  buffer_load_dwordx4 v[188:191], v3, s[28:31], s34 offen offset:2048 sc1
  v_mfma_f32_32x32x16_bf16 v[16:31], v[112:115], v[116:119], v[16:31]
  v_mfma_f32_32x32x16_bf16 v[32:47], v[112:115], v[124:127], v[32:47]
  v_mfma_f32_32x32x16_bf16 v[48:63], v[120:123], v[116:119], v[48:63]
  v_mfma_f32_32x32x16_bf16 v[64:79], v[120:123], v[124:127], v[64:79]
  s_waitcnt vmcnt(10)
  ds_read_b64_tr_b16 v[128:129], v250 offset:2048
  ds_read_b64_tr_b16 v[130:131], v250 offset:3072
  ds_read_b64_tr_b16 v[136:137], v251 offset:2048
  ds_read_b64_tr_b16 v[138:139], v251 offset:3072
  s_waitcnt lgkmcnt(0)
  s_add_u32 m0, s53, 2048
  s_nop 0
  buffer_load_dwordx4 v248, s[44:47], s35 offen lds
  buffer_load_dwordx4 v249, s[44:47], s35 offen offset:1024 lds
  s_add_u32 s35, s35, 16384
  buffer_load_dwordx4 v[196:199], v3, s[28:31], s33 offen offset:3072 sc1
  buffer_load_dwordx4 v[204:207], v3, s[28:31], s34 offen offset:3072 sc1
  s_add_u32 s42, s42, 1
  s_cmp_eq_u32 s42, 7
  s_movk_i32 s43, 4096
  s_cselect_b32 s43, 0xffffa000, s43
  s_cselect_b32 s42, 0, s42
  s_add_u32 s33, s33, s43
  s_add_u32 s34, s34, s43
  v_mfma_f32_32x32x16_bf16 v[16:31], v[128:131], v[132:135], v[16:31]
  v_mfma_f32_32x32x16_bf16 v[32:47], v[128:131], v[140:143], v[32:47]
  v_mfma_f32_32x32x16_bf16 v[48:63], v[136:139], v[132:135], v[48:63]
  v_mfma_f32_32x32x16_bf16 v[64:79], v[136:139], v[140:143], v[64:79]
  s_waitcnt vmcnt(10)
  ds_read_b64_tr_b16 v[144:145], v250 offset:4096
  ds_read_b64_tr_b16 v[146:147], v250 offset:5120
  ds_read_b64_tr_b16 v[152:153], v251 offset:4096
  ds_read_b64_tr_b16 v[154:155], v251 offset:5120
  s_waitcnt lgkmcnt(0)
  s_add_u32 m0, s53, 4096
  s_nop 0
  buffer_load_dwordx4 v248, s[44:47], s35 offen lds
  buffer_load_dwordx4 v249, s[44:47], s35 offen offset:1024 lds
  s_add_u32 s35, s35, 16384
  s_add_u32 s52, s52, 1
  s_cmp_eq_u32 s52, 7
  s_cselect_b32 s43, 0xfff90000, 0
  s_cselect_b32 s52, 0, s52
  s_add_u32 s35, s35, s43
  buffer_load_dwordx4 v[84:87], v3, s[28:31], s33 offen offset:0 sc1
  buffer_load_dwordx4 v[92:95], v3, s[28:31], s34 offen offset:0 sc1
  v_mfma_f32_32x32x16_bf16 v[16:31], v[144:147], v[148:151], v[16:31]
  v_mfma_f32_32x32x16_bf16 v[32:47], v[144:147], v[156:159], v[32:47]
  v_mfma_f32_32x32x16_bf16 v[48:63], v[152:155], v[148:151], v[48:63]
  v_mfma_f32_32x32x16_bf16 v[64:79], v[152:155], v[156:159], v[64:79]
  s_waitcnt vmcnt(10)
  ds_read_b64_tr_b16 v[160:161], v250 offset:0
  ds_read_b64_tr_b16 v[162:163], v250 offset:1024
  ds_read_b64_tr_b16 v[168:169], v251 offset:0
  ds_read_b64_tr_b16 v[170:171], v251 offset:1024
  s_waitcnt lgkmcnt(0)
  s_add_u32 m0, s53, 0
  s_nop 0
  buffer_load_dwordx4 v248, s[44:47], s35 offen lds
  buffer_load_dwordx4 v249, s[44:47], s35 offen offset:1024 lds
  s_add_u32 s35, s35, 16384
  buffer_load_dwordx4 v[100:103], v3, s[28:31], s33 offen offset:1024 sc1
  buffer_load_dwordx4 v[108:111], v3, s[28:31], s34 offen offset:1024 sc1
  v_mfma_f32_32x32x16_bf16 v[16:31], v[160:163], v[164:167], v[16:31]
  v_mfma_f32_32x32x16_bf16 v[32:47], v[160:163], v[172:175], v[32:47]
  v_mfma_f32_32x32x16_bf16 v[48:63], v[168:171], v[164:167], v[48:63]
  v_mfma_f32_32x32x16_bf16 v[64:79], v[168:171], v[172:175], v[64:79]
  s_waitcnt vmcnt(10)
  ds_read_b64_tr_b16 v[176:177], v250 offset:2048
  ds_read_b64_tr_b16 v[178:179], v250 offset:3072
  ds_read_b64_tr_b16 v[184:185], v251 offset:2048
  ds_read_b64_tr_b16 v[186:187], v251 offset:3072
  s_waitcnt lgkmcnt(0)
  s_add_u32 m0, s53, 2048
  s_nop 0
  buffer_load_dwordx4 v248, s[44:47], s35 offen lds
  buffer_load_dwordx4 v249, s[44:47], s35 offen offset:1024 lds
  s_add_u32 s35, s35, 16384
  buffer_load_dwordx4 v[116:119], v3, s[28:31], s33 offen offset:2048 sc1
  buffer_load_dwordx4 v[124:127], v3, s[28:31], s34 offen offset:2048 sc1
  v_mfma_f32_32x32x16_bf16 v[16:31], v[176:179], v[180:183], v[16:31]
  v_mfma_f32_32x32x16_bf16 v[32:47], v[176:179], v[188:191], v[32:47]
  v_mfma_f32_32x32x16_bf16 v[48:63], v[184:187], v[180:183], v[48:63]
  v_mfma_f32_32x32x16_bf16 v[64:79], v[184:187], v[188:191], v[64:79]
  s_waitcnt vmcnt(10)
  ds_read_b64_tr_b16 v[192:193], v250 offset:4096
  ds_read_b64_tr_b16 v[194:195], v250 offset:5120
  ds_read_b64_tr_b16 v[200:201], v251 offset:4096
  ds_read_b64_tr_b16 v[202:203], v251 offset:5120
  s_waitcnt lgkmcnt(0)
  s_add_u32 m0, s53, 4096
  s_nop 0
  buffer_load_dwordx4 v248, s[44:47], s35 offen lds
  buffer_load_dwordx4 v249, s[44:47], s35 offen offset:1024 lds
  s_add_u32 s35, s35, 16384
  buffer_load_dwordx4 v[132:135], v3, s[28:31], s33 offen offset:3072 sc1
  buffer_load_dwordx4 v[140:143], v3, s[28:31], s34 offen offset:3072 sc1
  s_add_u32 s42, s42, 1
  s_cmp_eq_u32 s42, 7
  s_movk_i32 s43, 4096
  s_cselect_b32 s43, 0xffffa000, s43
  s_cselect_b32 s42, 0, s42
  s_add_u32 s33, s33, s43
  s_add_u32 s34, s34, s43
  v_mfma_f32_32x32x16_bf16 v[16:31], v[192:195], v[196:199], v[16:31]
  v_mfma_f32_32x32x16_bf16 v[32:47], v[192:195], v[204:207], v[32:47]
  v_mfma_f32_32x32x16_bf16 v[48:63], v[200:203], v[196:199], v[48:63]
  v_mfma_f32_32x32x16_bf16 v[64:79], v[200:203], v[204:207], v[64:79]
  s_waitcnt vmcnt(10)
  ds_read_b64_tr_b16 v[80:81], v250 offset:0
  ds_read_b64_tr_b16 v[82:83], v250 offset:1024
  ds_read_b64_tr_b16 v[88:89], v251 offset:0
  ds_read_b64_tr_b16 v[90:91], v251 offset:1024
  s_waitcnt lgkmcnt(0)
  s_add_u32 m0, s53, 0
  s_nop 0
  buffer_load_dwordx4 v248, s[44:47], s35 offen lds
  buffer_load_dwordx4 v249, s[44:47], s35 offen offset:1024 lds
  s_add_u32 s35, s35, 16384
  s_add_u32 s52, s52, 1
  s_cmp_eq_u32 s52, 7
  s_cselect_b32 s43, 0xfff90000, 0
  s_cselect_b32 s52, 0, s52
  s_add_u32 s35, s35, s43
  v_mfma_f32_32x32x16_bf16 v[16:31], v[80:83], v[84:87], v[16:31]
  v_mfma_f32_32x32x16_bf16 v[32:47], v[80:83], v[92:95], v[32:47]
  v_mfma_f32_32x32x16_bf16 v[48:63], v[88:91], v[84:87], v[48:63]
  v_mfma_f32_32x32x16_bf16 v[64:79], v[88:91], v[92:95], v[64:79]
  s_waitcnt vmcnt(8)
  ds_read_b64_tr_b16 v[96:97], v250 offset:2048
  ds_read_b64_tr_b16 v[98:99], v250 offset:3072
  ds_read_b64_tr_b16 v[104:105], v251 offset:2048
  ds_read_b64_tr_b16 v[106:107], v251 offset:3072
  s_waitcnt lgkmcnt(0)
  s_add_u32 m0, s53, 2048
  s_nop 0
  buffer_load_dwordx4 v248, s[48:51], s39 offen lds
  buffer_load_dwordx4 v249, s[48:51], s39 offen offset:1024 lds
  s_add_u32 s39, s39, 16384
  v_mfma_f32_32x32x16_bf16 v[16:31], v[96:99], v[100:103], v[16:31]
  v_mfma_f32_32x32x16_bf16 v[32:47], v[96:99], v[108:111], v[32:47]
  v_mfma_f32_32x32x16_bf16 v[48:63], v[104:107], v[100:103], v[48:63]
  v_mfma_f32_32x32x16_bf16 v[64:79], v[104:107], v[108:111], v[64:79]
  s_waitcnt vmcnt(6)
  ds_read_b64_tr_b16 v[112:113], v250 offset:4096
  ds_read_b64_tr_b16 v[114:115], v250 offset:5120
  ds_read_b64_tr_b16 v[120:121], v251 offset:4096
  ds_read_b64_tr_b16 v[122:123], v251 offset:5120
  s_waitcnt lgkmcnt(0)
  s_add_u32 m0, s53, 4096
  s_nop 0
  buffer_load_dwordx4 v248, s[48:51], s39 offen lds
  buffer_load_dwordx4 v249, s[48:51], s39 offen offset:1024 lds
  s_add_u32 s39, s39, 16384
  v_mfma_f32_32x32x16_bf16 v[16:31], v[112:115], v[116:119], v[16:31]
  v_mfma_f32_32x32x16_bf16 v[32:47], v[112:115], v[124:127], v[32:47]
  v_mfma_f32_32x32x16_bf16 v[48:63], v[120:123], v[116:119], v[48:63]
  v_mfma_f32_32x32x16_bf16 v[64:79], v[120:123], v[124:127], v[64:79]
  s_waitcnt vmcnt(4)
  ds_read_b64_tr_b16 v[128:129], v250 offset:0
  ds_read_b64_tr_b16 v[130:131], v250 offset:1024
  ds_read_b64_tr_b16 v[136:137], v251 offset:0
  ds_read_b64_tr_b16 v[138:139], v251 offset:1024
  s_waitcnt lgkmcnt(0)
  s_add_u32 m0, s53, 0
  s_nop 0
  buffer_load_dwordx4 v248, s[48:51], s39 offen lds
  buffer_load_dwordx4 v249, s[48:51], s39 offen offset:1024 lds
  s_add_u32 s39, s39, 16384
  v_mfma_f32_32x32x16_bf16 v[16:31], v[128:131], v[132:135], v[16:31]
  v_mfma_f32_32x32x16_bf16 v[32:47], v[128:131], v[140:143], v[32:47]
  v_mfma_f32_32x32x16_bf16 v[48:63], v[136:139], v[132:135], v[48:63]
  v_mfma_f32_32x32x16_bf16 v[64:79], v[136:139], v[140:143], v[64:79]
  s_waitcnt vmcnt(4)
  ds_read_b64_tr_b16 v[144:145], v250 offset:2048
  ds_read_b64_tr_b16 v[146:147], v250 offset:3072
  ds_read_b64_tr_b16 v[152:153], v251 offset:2048
  ds_read_b64_tr_b16 v[154:155], v251 offset:3072
  s_waitcnt lgkmcnt(0)
  s_add_u32 m0, s53, 2048
  s_nop 0
  buffer_load_dwordx4 v248, s[48:51], s39 offen lds
  buffer_load_dwordx4 v249, s[48:51], s39 offen offset:1024 lds
  s_add_u32 s39, s39, 16384
  s_waitcnt vmcnt(4)
  ds_read_b64_tr_b16 v[160:161], v250 offset:4096
  ds_read_b64_tr_b16 v[162:163], v250 offset:5120
  ds_read_b64_tr_b16 v[168:169], v251 offset:4096
  ds_read_b64_tr_b16 v[170:171], v251 offset:5120
  s_waitcnt lgkmcnt(0)
  s_add_u32 m0, s53, 4096
  s_nop 0
  buffer_load_dwordx4 v248, s[48:51], s39 offen lds
  buffer_load_dwordx4 v249, s[48:51], s39 offen offset:1024 lds
  s_add_u32 s39, s39, 16384
  s_waitcnt vmcnt(4)
  ds_read_b64_tr_b16 v[176:177], v250 offset:0
  ds_read_b64_tr_b16 v[178:179], v250 offset:1024
  ds_read_b64_tr_b16 v[184:185], v251 offset:0
  ds_read_b64_tr_b16 v[186:187], v251 offset:1024
  s_waitcnt lgkmcnt(0)
  s_add_u32 m0, s53, 0
  s_nop 0
  buffer_load_dwordx4 v248, s[48:51], s39 offen lds
  buffer_load_dwordx4 v249, s[48:51], s39 offen offset:1024 lds
  s_add_u32 s39, s39, 16384
  s_waitcnt vmcnt(4)
  ds_read_b64_tr_b16 v[192:193], v250 offset:2048
  ds_read_b64_tr_b16 v[194:195], v250 offset:3072
  ds_read_b64_tr_b16 v[200:201], v251 offset:2048
  ds_read_b64_tr_b16 v[202:203], v251 offset:3072
  s_waitcnt lgkmcnt(0)
  s_add_u32 m0, s53, 2048
  s_nop 0
  buffer_load_dwordx4 v248, s[48:51], s39 offen lds
  buffer_load_dwordx4 v249, s[48:51], s39 offen offset:1024 lds
  s_add_u32 s39, s39, 16384
  s_waitcnt vmcnt(4)
  ds_read_b64_tr_b16 v[80:81], v250 offset:4096
  ds_read_b64_tr_b16 v[82:83], v250 offset:5120
  ds_read_b64_tr_b16 v[88:89], v251 offset:4096
  ds_read_b64_tr_b16 v[90:91], v251 offset:5120
  s_waitcnt lgkmcnt(0)
  s_add_u32 m0, s53, 4096
  s_nop 0
  buffer_load_dwordx4 v248, s[48:51], s39 offen lds
  buffer_load_dwordx4 v249, s[48:51], s39 offen offset:1024 lds
  s_add_u32 s39, s39, 16384
  s_waitcnt vmcnt(4)
  ds_read_b64_tr_b16 v[96:97], v250 offset:0
  ds_read_b64_tr_b16 v[98:99], v250 offset:1024
  ds_read_b64_tr_b16 v[104:105], v251 offset:0
  ds_read_b64_tr_b16 v[106:107], v251 offset:1024
  s_waitcnt lgkmcnt(0)
  s_waitcnt vmcnt(2)
  ds_read_b64_tr_b16 v[112:113], v250 offset:2048
  ds_read_b64_tr_b16 v[114:115], v250 offset:3072
  ds_read_b64_tr_b16 v[120:121], v251 offset:2048
  ds_read_b64_tr_b16 v[122:123], v251 offset:3072
  s_waitcnt lgkmcnt(0)
  s_waitcnt vmcnt(0)
  ds_read_b64_tr_b16 v[128:129], v250 offset:4096
  ds_read_b64_tr_b16 v[130:131], v250 offset:5120
  ds_read_b64_tr_b16 v[136:137], v251 offset:4096
  ds_read_b64_tr_b16 v[138:139], v251 offset:5120
  s_waitcnt lgkmcnt(0)
  s_lshl_b32 s24, s72, 2
  s_add_u32 s24, s24, s23
  s_lshl_b32 s24, s24, 14
  s_add_u32 s24, s24, 14024704
  s_lshl_b32 s26, s72, 12
  s_lshl_b32 s25, s23, 10
  s_add_u32 s26, s26, s25
  s_add_u32 s26, s26, 16384000
  s_mov_b32 s54, 0
  s_mov_b32 s74, 200000
K3_PRE:
  s_barrier
K3_GO:
  s_mov_b32 s74, 200000
  v_mov_b32 v8, 0
  v_mov_b32 v9, 0
  s_xor_b32 exec_lo, s54, 0xff
  s_mov_b32 exec_hi, 0
  buffer_atomic_or_x2 v[8:9], v233, s[28:31], s26 offen sc0 sc1
  s_mov_b64 exec, -1
  v_sub_f32 v240, 1.0, v240
  v_sub_f32 v242, 1.0, v242
  v_pk_mul_f32 v[16:17], v[16:17], v[240:241] op_sel_hi:[1,0]
  v_pk_mul_f32 v[18:19], v[18:19], v[240:241] op_sel_hi:[1,0]
  v_pk_mul_f32 v[20:21], v[20:21], v[240:241] op_sel_hi:[1,0]
  v_pk_mul_f32 v[22:23], v[22:23], v[240:241] op_sel_hi:[1,0]
  v_pk_mul_f32 v[24:25], v[24:25], v[240:241] op_sel_hi:[1,0]
  v_pk_mul_f32 v[26:27], v[26:27], v[240:241] op_sel_hi:[1,0]
  v_pk_mul_f32 v[28:29], v[28:29], v[240:241] op_sel_hi:[1,0]
  v_pk_mul_f32 v[30:31], v[30:31], v[240:241] op_sel_hi:[1,0]
  v_pk_mul_f32 v[32:33], v[32:33], v[242:243] op_sel_hi:[1,0]
  v_pk_mul_f32 v[34:35], v[34:35], v[242:243] op_sel_hi:[1,0]
  v_pk_mul_f32 v[36:37], v[36:37], v[242:243] op_sel_hi:[1,0]
  v_pk_mul_f32 v[38:39], v[38:39], v[242:243] op_sel_hi:[1,0]
  v_pk_mul_f32 v[40:41], v[40:41], v[242:243] op_sel_hi:[1,0]
  v_pk_mul_f32 v[42:43], v[42:43], v[242:243] op_sel_hi:[1,0]
  v_pk_mul_f32 v[44:45], v[44:45], v[242:243] op_sel_hi:[1,0]
  v_pk_mul_f32 v[46:47], v[46:47], v[242:243] op_sel_hi:[1,0]
  v_pk_mul_f32 v[48:49], v[48:49], v[240:241] op_sel_hi:[1,0]
  v_pk_mul_f32 v[50:51], v[50:51], v[240:241] op_sel_hi:[1,0]
  v_pk_mul_f32 v[52:53], v[52:53], v[240:241] op_sel_hi:[1,0]
  v_pk_mul_f32 v[54:55], v[54:55], v[240:241] op_sel_hi:[1,0]
  v_pk_mul_f32 v[56:57], v[56:57], v[240:241] op_sel_hi:[1,0]
  v_pk_mul_f32 v[58:59], v[58:59], v[240:241] op_sel_hi:[1,0]
  v_pk_mul_f32 v[60:61], v[60:61], v[240:241] op_sel_hi:[1,0]
  v_pk_mul_f32 v[62:63], v[62:63], v[240:241] op_sel_hi:[1,0]
  v_pk_mul_f32 v[64:65], v[64:65], v[242:243] op_sel_hi:[1,0]
  v_pk_mul_f32 v[66:67], v[66:67], v[242:243] op_sel_hi:[1,0]
  v_pk_mul_f32 v[68:69], v[68:69], v[242:243] op_sel_hi:[1,0]
  v_pk_mul_f32 v[70:71], v[70:71], v[242:243] op_sel_hi:[1,0]
  v_pk_mul_f32 v[72:73], v[72:73], v[242:243] op_sel_hi:[1,0]
  v_pk_mul_f32 v[74:75], v[74:75], v[242:243] op_sel_hi:[1,0]
  v_pk_mul_f32 v[76:77], v[76:77], v[242:243] op_sel_hi:[1,0]
  v_pk_mul_f32 v[78:79], v[78:79], v[242:243] op_sel_hi:[1,0]
  s_branch K3_ROUND
K3_POLL:
  v_mov_b32 v8, 0
  v_mov_b32 v9, 0
  s_xor_b32 exec_lo, s54, 0xff
  s_mov_b32 exec_hi, 0
  buffer_atomic_or_x2 v[8:9], v233, s[28:31], s26 offen sc0 sc1
  s_mov_b64 exec, -1
K3_ROUND:
  s_waitcnt vmcnt(0)
  v_cmp_eq_u64 vcc, s[68:69], v[8:9]
  s_sub_u32 s74, s74, 1
  s_cselect_b32 s55, 0xff, vcc_lo
  s_andn2_b32 s55, s55, s54
  s_cbranch_scc1 K3_SOME
  s_sleep 2
  s_branch K3_POLL
K3_SOME:
  s_or_b32 s54, s54, s55
  s_bitcmp1_b32 s55, 0
  s_cbranch_scc0 K3_L0
  s_add_u32 s25, s24, 0
  buffer_load_dwordx4 v[148:151], v3, s[28:31], s25 offen sc1
  buffer_load_dwordx4 v[156:159], v3, s[28:31], s25 offen offset:1024 sc1
K3_L0:
  s_bitcmp1_b32 s55, 1
  s_cbranch_scc0 K3_L1
  s_add_u32 s25, s24, 2048
  buffer_load_dwordx4 v[164:167], v3, s[28:31], s25 offen sc1
  buffer_load_dwordx4 v[172:175], v3, s[28:31], s25 offen offset:1024 sc1
K3_L1:
  s_bitcmp1_b32 s55, 2
  s_cbranch_scc0 K3_L2
  s_add_u32 s25, s24, 4096
  buffer_load_dwordx4 v[180:183], v3, s[28:31], s25 offen sc1
  buffer_load_dwordx4 v[188:191], v3, s[28:31], s25 offen offset:1024 sc1
K3_L2:
  s_bitcmp1_b32 s55, 3
  s_cbranch_scc0 K3_L3
  s_add_u32 s25, s24, 6144
  buffer_load_dwordx4 v[196:199], v3, s[28:31], s25 offen sc1
  buffer_load_dwordx4 v[204:207], v3, s[28:31], s25 offen offset:1024 sc1
K3_L3:
  s_bitcmp1_b32 s55, 4
  s_cbranch_scc0 K3_L4
  s_add_u32 s25, s24, 8192
  buffer_load_dwordx4 v[84:87], v3, s[28:31], s25 offen sc1
  buffer_load_dwordx4 v[92:95], v3, s[28:31], s25 offen offset:1024 sc1
K3_L4:
  s_bitcmp1_b32 s55, 5
  s_cbranch_scc0 K3_L5
  s_add_u32 s25, s24, 10240
  buffer_load_dwordx4 v[100:103], v3, s[28:31], s25 offen sc1
  buffer_load_dwordx4 v[108:111], v3, s[28:31], s25 offen offset:1024 sc1
K3_L5:
  s_bitcmp1_b32 s55, 6
  s_cbranch_scc0 K3_L6
  s_add_u32 s25, s24, 12288
  buffer_load_dwordx4 v[116:119], v3, s[28:31], s25 offen sc1
  buffer_load_dwordx4 v[124:127], v3, s[28:31], s25 offen offset:1024 sc1
K3_L6:
  s_bitcmp1_b32 s55, 7
  s_cbranch_scc0 K3_L7
  s_add_u32 s25, s24, 14336
  buffer_load_dwordx4 v[132:135], v3, s[28:31], s25 offen sc1
  buffer_load_dwordx4 v[140:143], v3, s[28:31], s25 offen offset:1024 sc1
K3_L7:
K3_NEXTP:
  s_waitcnt vmcnt(0)
  s_cmp_eq_u32 s54, 0xff
  s_cbranch_scc1 K3_LAST
  v_mov_b32 v8, 0
  v_mov_b32 v9, 0
  s_xor_b32 exec_lo, s54, 0xff
  s_mov_b32 exec_hi, 0
  buffer_atomic_or_x2 v[8:9], v233, s[28:31], s26 offen sc0 sc1
  s_mov_b64 exec, -1
K3_LAST:
  s_bitcmp1_b32 s55, 0
  s_cbranch_scc0 K3_C0
  v_mfma_f32_32x32x16_bf16 v[16:31], v[144:147], v[148:151], v[16:31]
  v_mfma_f32_32x32x16_bf16 v[32:47], v[144:147], v[156:159], v[32:47]
  v_mfma_f32_32x32x16_bf16 v[48:63], v[152:155], v[148:151], v[48:63]
  v_mfma_f32_32x32x16_bf16 v[64:79], v[152:155], v[156:159], v[64:79]
K3_C0:
  s_bitcmp1_b32 s55, 1
  s_cbranch_scc0 K3_C1
  v_mfma_f32_32x32x16_bf16 v[16:31], v[160:163], v[164:167], v[16:31]
  v_mfma_f32_32x32x16_bf16 v[32:47], v[160:163], v[172:175], v[32:47]
  v_mfma_f32_32x32x16_bf16 v[48:63], v[168:171], v[164:167], v[48:63]
  v_mfma_f32_32x32x16_bf16 v[64:79], v[168:171], v[172:175], v[64:79]
K3_C1:
  s_bitcmp1_b32 s55, 2
  s_cbranch_scc0 K3_C2
  v_mfma_f32_32x32x16_bf16 v[16:31], v[176:179], v[180:183], v[16:31]
  v_mfma_f32_32x32x16_bf16 v[32:47], v[176:179], v[188:191], v[32:47]
  v_mfma_f32_32x32x16_bf16 v[48:63], v[184:187], v[180:183], v[48:63]
  v_mfma_f32_32x32x16_bf16 v[64:79], v[184:187], v[188:191], v[64:79]
K3_C2:
  s_bitcmp1_b32 s55, 3
  s_cbranch_scc0 K3_C3
  v_mfma_f32_32x32x16_bf16 v[16:31], v[192:195], v[196:199], v[16:31]
  v_mfma_f32_32x32x16_bf16 v[32:47], v[192:195], v[204:207], v[32:47]
  v_mfma_f32_32x32x16_bf16 v[48:63], v[200:203], v[196:199], v[48:63]
  v_mfma_f32_32x32x16_bf16 v[64:79], v[200:203], v[204:207], v[64:79]
K3_C3:
  s_bitcmp1_b32 s55, 4
  s_cbranch_scc0 K3_C4
  v_mfma_f32_32x32x16_bf16 v[16:31], v[80:83], v[84:87], v[16:31]
  v_mfma_f32_32x32x16_bf16 v[32:47], v[80:83], v[92:95], v[32:47]
  v_mfma_f32_32x32x16_bf16 v[48:63], v[88:91], v[84:87], v[48:63]
  v_mfma_f32_32x32x16_bf16 v[64:79], v[88:91], v[92:95], v[64:79]
K3_C4:
  s_bitcmp1_b32 s55, 5
  s_cbranch_scc0 K3_C5
  v_mfma_f32_32x32x16_bf16 v[16:31], v[96:99], v[100:103], v[16:31]
  v_mfma_f32_32x32x16_bf16 v[32:47], v[96:99], v[108:111], v[32:47]
  v_mfma_f32_32x32x16_bf16 v[48:63], v[104:107], v[100:103], v[48:63]
  v_mfma_f32_32x32x16_bf16 v[64:79], v[104:107], v[108:111], v[64:79]
K3_C5:
  s_bitcmp1_b32 s55, 6
  s_cbranch_scc0 K3_C6
  v_mfma_f32_32x32x16_bf16 v[16:31], v[112:115], v[116:119], v[16:31]
  v_mfma_f32_32x32x16_bf16 v[32:47], v[112:115], v[124:127], v[32:47]
  v_mfma_f32_32x32x16_bf16 v[48:63], v[120:123], v[116:119], v[48:63]
  v_mfma_f32_32x32x16_bf16 v[64:79], v[120:123], v[124:127], v[64:79]
K3_C6:
  s_bitcmp1_b32 s55, 7
  s_cbranch_scc0 K3_C7
  v_mfma_f32_32x32x16_bf16 v[16:31], v[128:131], v[132:135], v[16:31]
  v_mfma_f32_32x32x16_bf16 v[32:47], v[128:131], v[140:143], v[32:47]
  v_mfma_f32_32x32x16_bf16 v[48:63], v[136:139], v[132:135], v[48:63]
  v_mfma_f32_32x32x16_bf16 v[64:79], v[136:139], v[140:143], v[64:79]
K3_C7:
  s_cmp_lg_u32 s54, 0xff
  s_cbranch_scc1 K3_ROUND
  s_nop 7
  ds_write_b128 v212, v[16:19] offset:0
  ds_write_b128 v213, v[20:23] offset:0
  ds_write_b128 v214, v[24:27] offset:0
  ds_write_b128 v215, v[28:31] offset:0
  ds_write_b128 v212, v[32:35] offset:8192
  ds_write_b128 v213, v[36:39] offset:8192
  ds_write_b128 v214, v[40:43] offset:8192
  ds_write_b128 v215, v[44:47] offset:8192
  ds_write_b128 v212, v[48:51] offset:128
  ds_write_b128 v213, v[52:55] offset:128
  ds_write_b128 v214, v[56:59] offset:128
  ds_write_b128 v215, v[60:63] offset:128
  ds_write_b128 v212, v[64:67] offset:8320
  ds_write_b128 v213, v[68:71] offset:8320
  ds_write_b128 v214, v[72:75] offset:8320
  ds_write_b128 v215, v[76:79] offset:8320
K3_REDUCE:
  s_mov_b32 s24, s64
  s_mov_b32 s25, s65
  s_mov_b32 s26, 0x200000
  s_mov_b32 s27, 0x20000
  s_lshl_b32 s32, s20, 6
  v_add_u32 v0, s32, v2
  v_lshrrev_b32 v7, 3, v0
  v_and_b32 v5, 7, v0
  v_lshlrev_b32 v6, 1, v5
  v_and_b32 v8, 7, v7
  v_xor_b32 v6, v6, v8
  v_lshlrev_b32 v6, 4, v6
  v_lshl_add_u32 v6, v7, 8, v6
  v_xor_b32 v8, 16, v6
  v_add_u32 v9, 0x10000, v6
  v_add_u32 v10, 0x10000, v8
  v_lshlrev_b32 v7, 10, v7
  v_lshl_add_u32 v7, v5, 4, v7
  s_lshl_b32 s32, s72, 16
  s_lshl_b32 s33, s73, 7
  s_add_u32 s32, s32, s33
  s_waitcnt lgkmcnt(0)
  s_barrier
  ds_read_b128 v[96:99], v6 offset:0
  ds_read_b128 v[100:103], v8 offset:0
  ds_read_b128 v[104:107], v6 offset:16384
  ds_read_b128 v[108:111], v8 offset:16384
  ds_read_b128 v[112:115], v6 offset:32768
  ds_read_b128 v[116:119], v8 offset:32768
  ds_read_b128 v[120:123], v6 offset:49152
  ds_read_b128 v[124:127], v8 offset:49152
  s_waitcnt lgkmcnt(4)
  v_pk_add_f32 v[96:97], v[96:97], v[104:105]
  v_pk_add_f32 v[98:99], v[98:99], v[106:107]
  v_pk_add_f32 v[100:101], v[100:101], v[108:109]
  v_pk_add_f32 v[102:103], v[102:103], v[110:111]
  s_waitcnt lgkmcnt(2)
  v_pk_add_f32 v[96:97], v[96:97], v[112:113]
  v_pk_add_f32 v[98:99], v[98:99], v[114:115]
  v_pk_add_f32 v[100:101], v[100:101], v[116:117]
  v_pk_add_f32 v[102:103], v[102:103], v[118:119]
  s_waitcnt lgkmcnt(0)
  v_pk_add_f32 v[96:97], v[96:97], v[120:121]
  v_pk_add_f32 v[98:99], v[98:99], v[122:123]
  v_pk_add_f32 v[100:101], v[100:101], v[124:125]
  v_pk_add_f32 v[102:103], v[102:103], v[126:127]
  v_cvt_pk_bf16_f32 v16, v96, v97
  v_cvt_pk_bf16_f32 v17, v98, v99
  v_cvt_pk_bf16_f32 v18, v100, v101
  v_cvt_pk_bf16_f32 v19, v102, v103
  buffer_store_dwordx4 v[16:19], v7, s[24:27], s32 offen sc1
K_EXIT:
  s_endpgm
K_END:
.section .rodata,"a"
.p2align 6
.amdhsa_kernel gated_mix__softmax_full_mha__geglu_ffn__prompt_kernel
  .amdhsa_next_free_vgpr 256
  .amdhsa_next_free_sgpr 102
  .amdhsa_accum_offset 256
  .amdhsa_group_segment_fixed_size 0
  .amdhsa_kernarg_size 88
  .amdhsa_user_sgpr_count 2
  .amdhsa_user_sgpr_kernarg_segment_ptr 1
  .amdhsa_system_sgpr_workgroup_id_x 1
.end_amdhsa_kernel
```
